```python
import torch

def _softmax(x, axis=-1):
    return torch.softmax(x, dim=axis)
def _gelu(x):
    return torch.nn.functional.gelu(x, approximate="tanh")
def _silu(x):
    return torch.nn.functional.silu(x)
def _sigmoid(x):
    return torch.sigmoid(x)
def _layernorm(x, axis=-1, eps=1e-5):
    m = x.mean(dim=axis, keepdim=True)
    v = x.var(dim=axis, keepdim=True, unbiased=False)
    return (x - m) / torch.sqrt(v + eps)
def _scatter_add(tgt, idx, src, axis=0):
    return tgt.clone().index_add_(axis, idx, src)
def _segment_sum(src, seg, n):
    out = torch.zeros((n,) + src.shape[1:], dtype=src.dtype)
    return out.index_add_(0, seg, src)
def _pad(x, pw):
    flat = tuple(v for pair in reversed(pw) for v in pair)
    return torch.nn.functional.pad(x, flat)

kernel_name = 'standalone__gqa_block_cached__near_ridge'

def setup_inputs():

    _w = (lambda a: (lambda t: t.to(torch.bfloat16) if t.is_floating_point() else t)(torch.as_tensor(a)))
    B, Sq, D = 8, 64, 576
    Hq, Hkv, Sk, Dh = 32, 16, 512, 128
    assert Hq % Hkv == 0, (Hq, Hkv)
    return {
        "x": _w((lambda *s: torch.randn(*s, dtype=torch.bfloat16) * 0.8)(B, Sq, D)),
        "k_cache": _w((lambda *s: torch.randn(*s, dtype=torch.bfloat16) * 0.8)(B, Hkv, Sk, Dh)),
        "v_cache": _w((lambda *s: torch.randn(*s, dtype=torch.bfloat16) * 0.05)(B, Hkv, Sk, Dh)),
        "wq": _w((lambda *s: torch.randn(*s, dtype=torch.bfloat16) * 0.8)(D, Hq * Dh) * (D ** -0.5)),
        "wo": _w((lambda *s: torch.randn(*s, dtype=torch.bfloat16) * 0.05)(Hq * Dh, D) * ((Hq * Dh) ** -0.5)),
    }

def reference(x, k_cache, v_cache, wq, wo):
    B, Sq, D = x.shape
    Hq, Dh = 32, 128
    Hkv = k_cache.shape[1]
    rep = Hq // Hkv
    q = (lambda x, *d: x.permute(*d))((x @ wq).reshape(B, Sq, Hq, Dh), 0, 2, 1, 3)
    k = (lambda x, n, axis: torch.repeat_interleave(x, n, dim=axis))(k_cache, rep, axis=1)
    v = (lambda x, n, axis: torch.repeat_interleave(x, n, dim=axis))(v_cache, rep, axis=1)
    scores = torch.einsum("bhqd,bhkd->bhqk", q, k) * (Dh ** -0.5)
    p = _softmax(scores, axis=-1)
    o = torch.einsum("bhqk,bhkd->bhqd", p, v)
    return (lambda x, *d: x.permute(*d))(o, 0, 2, 1, 3).reshape(B, Sq, Hq * Dh) @ wo
```

```asm
; @launch grid=(256,1,1) block=(512,1,1) lds=163840
.amdgcn_target "amdgcn-amd-amdhsa--gfx950"
.text
.globl standalone__gqa_block_cached__near_ridge_kernel
.p2align 8
.type standalone__gqa_block_cached__near_ridge_kernel,@function
standalone__gqa_block_cached__near_ridge_kernel:
  s_cmp_ge_u32 s2, 256
  s_cbranch_scc1 L_END
  s_load_dwordx16 s[36:51], s[0:1], 0
  v_lshrrev_b32 v2, 6, v0
  v_and_b32 v1, 63, v0
  s_mov_b32 s59, s2
  v_readfirstlane_b32 s56, v2
  s_and_b32 s52, s2, 7
  s_lshr_b32 s53, s2, 3
  s_and_b32 s53, s53, 3
  s_lshr_b32 s54, s2, 5
  s_lshl_b32 s55, s52, 2
  s_add_u32 s55, s55, s53
  v_lshrrev_b32 v2, 4, v1
  v_and_b32 v3, 15, v1
  s_mov_b32 s92, 0
  s_mov_b32 s94, 0
  s_mov_b32 s93, 0x80000
  s_cmp_lt_u32 s56, 4
  s_cbranch_scc1 L_COMPUTE
L_LOADER:
  s_sub_u32 s57, s56, 4
  s_lshl_b32 s66, s57, 12
  v_lshlrev_b32 v30, 2, v1
  v_add_u32 v30, 0x26000, v30
  v_mov_b32 v31, 0
  s_cmp_eq_u32 s57, 0
  s_cbranch_scc0 L_NOINIT
  ds_write_b32 v30, v31
L_NOINIT:
  v_lshrrev_b32 v30, 3, v1
  v_mul_u32_u24 v30, 1152, v30
  v_and_b32 v31, 7, v1
  v_xor_b32 v31, v31, v2
  v_lshl_add_u32 v30, v31, 4, v30
  v_add_u32 v4, 0, v30
  v_lshrrev_b32 v30, 3, v1
  v_mul_u32_u24 v30, 1152, v30
  v_and_b32 v31, 7, v1
  v_xor_b32 v31, v31, v2
  v_xor_b32 v31, 4, v31
  v_lshl_add_u32 v30, v31, 4, v30
  v_add_u32 v5, 8192, v30
  v_lshlrev_b32 v31, 2, v2
  v_xor_b32 v31, v31, v3
  v_lshlrev_b32 v31, 4, v31
  v_lshl_add_u32 v30, v2, 13, v31
  v_add_u32 v6, 0, v30
  v_add_u32 v7, 31744, v30
  v_add_u32 v8, 63488, v30
  v_add_u32 v9, 95232, v30
  s_mul_i32 s7, s53, 0
  s_add_u32 s7, s7, s54
  s_cmp_ge_u32 s7, 9
  s_cselect_b32 s61, 9, 0
  s_sub_u32 s7, s7, s61
  s_mul_i32 s67, s57, 18432
  s_lshl_b32 s68, s57, 17
  s_waitcnt lgkmcnt(0)
  s_mul_i32 s60, s54, 73728
  s_add_u32 s8, s36, s60
  s_addc_u32 s9, s37, 0
  s_mov_b32 s10, 0x12000
  s_mov_b32 s11, 0x00020000
  s_lshl_b32 s60, s55, 8
  s_add_u32 s12, s42, s60
  s_addc_u32 s13, s43, 0
  s_mov_b32 s14, 0x47e100
  s_mov_b32 s15, 0x00020000
  s_lshl_b32 s60, s53, 2
  s_add_u32 s60, s60, s57
  s_mul_i32 s60, s60, 4608
  v_lshlrev_b32 v40, 7, v1
  v_lshrrev_b32 v42, 1, v1
  v_lshlrev_b32 v42, 13, v42
  v_and_b32 v43, 1, v1
  v_lshl_add_u32 v42, v43, 7, v42
  s_mul_i32 s61, s54, 72
  s_mul_i32 s62, s57, 18
  s_add_u32 s61, s61, s62
  s_lshl_b32 s61, s61, 13
  s_mov_b32 exec_lo, -1
  s_mov_b32 exec_hi, 0xf
  s_mov_b32 s6, s60
  s_mov_b64 exec, -1
  s_add_u32 s60, s7, 0
  s_cmp_ge_u32 s60, 9
  s_cselect_b32 s61, 9, 0
  s_sub_u32 s69, s60, s61
  s_lshl_b32 s60, s69, 7
  s_lshr_b32 s61, s66, 1
  s_add_u32 m0, s61, 131072
  s_add_u32 s60, s60, s67
  buffer_load_dwordx4 v4, s[8:11], s60 offen offset:0 lds
  buffer_load_dwordx4 v5, s[8:11], s60 offen offset:1024 lds
  s_lshl_b32 s60, s69, 19
  s_add_u32 m0, s66, 0
  s_add_u32 s60, s60, s68
  buffer_load_dwordx4 v6, s[12:15], s60 offen offset:0 lds
  buffer_load_dwordx4 v7, s[12:15], s60 offen offset:1024 lds
  buffer_load_dwordx4 v8, s[12:15], s60 offen offset:2048 lds
  buffer_load_dwordx4 v9, s[12:15], s60 offen offset:3072 lds
  s_mov_b32 exec_lo, -1
  s_mov_b32 exec_hi, 0xf
  buffer_load_dword v41, v40, s[8:11], s6 offen
  s_mov_b64 exec, -1
  v_mov_b32 v24, 0x26000
  s_lshl_b32 s60, s57, 2
  s_add_u32 s60, s60, 0x26000
  v_mov_b32 v25, s60
  s_waitcnt lgkmcnt(0)
  s_barrier
  ds_read_b128 v[108:111], v24 offset:16
  s_add_u32 s60, s7, 1
  s_cmp_ge_u32 s60, 9
  s_cselect_b32 s61, 9, 0
  s_sub_u32 s69, s60, s61
  s_lshl_b32 s60, s69, 7
  s_lshr_b32 s61, s66, 1
  s_add_u32 m0, s61, 139264
  s_add_u32 s60, s60, s67
  buffer_load_dwordx4 v4, s[8:11], s60 offen offset:0 lds
  buffer_load_dwordx4 v5, s[8:11], s60 offen offset:1024 lds
  s_lshl_b32 s60, s69, 19
  s_add_u32 m0, s66, 16384
  s_add_u32 s60, s60, s68
  buffer_load_dwordx4 v6, s[12:15], s60 offen offset:0 lds
  buffer_load_dwordx4 v7, s[12:15], s60 offen offset:1024 lds
  buffer_load_dwordx4 v8, s[12:15], s60 offen offset:2048 lds
  buffer_load_dwordx4 v9, s[12:15], s60 offen offset:3072 lds
  s_waitcnt lgkmcnt(0)
  v_min3_u32 v108, v108, v109, v110
  v_min_u32 v108, v108, v111
  s_nop 0
  v_readfirstlane_b32 s92, v108
  s_mov_b32 s28, s50
  s_mov_b32 s29, s51
  s_mov_b32 s30, 0x10000000
  s_mov_b32 s31, 0x00020000
  s_lshl_b32 s60, s54, 7
  v_mov_b32 v38, s60
  buffer_load_dword v39, v38, s[28:31], 0 offen sc1
  v_lshl_add_u32 v14, v2, 8, v31
  v_mul_u32_u24 v30, 1152, v2
  v_add_u32 v30, v30, v31
  v_add_u32 v15, 0, v30
  v_add_u32 v16, 3584, v30
  v_add_u32 v17, 7168, v30
  v_add_u32 v18, 10752, v30
  v_add_u32 v30, 0, v2
  v_xor_b32 v30, v30, v3
  v_lshlrev_b32 v30, 4, v30
  v_lshl_add_u32 v10, v2, 8, v30
  v_add_u32 v30, 4, v2
  v_xor_b32 v30, v30, v3
  v_lshlrev_b32 v30, 4, v30
  v_lshl_add_u32 v11, v2, 8, v30
  v_add_u32 v30, 8, v2
  v_xor_b32 v30, v30, v3
  v_lshlrev_b32 v30, 4, v30
  v_lshl_add_u32 v12, v2, 8, v30
  v_add_u32 v30, 12, v2
  v_xor_b32 v30, v30, v3
  v_lshlrev_b32 v30, 4, v30
  v_lshl_add_u32 v13, v2, 8, v30
  v_lshrrev_b32 v30, 1, v1
  v_mul_u32_u24 v30, 1152, v30
  v_and_b32 v31, 1, v1
  v_lshl_add_u32 v30, v31, 4, v30
  v_add_u32 v19, 0, v30
  v_add_u32 v20, 35840, v30
  v_add_u32 v21, 71680, v30
  v_add_u32 v22, 107520, v30
  v_lshlrev_b32 v23, 4, v1
  s_lshr_b32 s60, s55, 1
  s_lshl_b32 s61, s54, 4
  s_add_u32 s60, s60, s61
  s_lshl_b32 s60, s60, 17
  s_add_u32 s16, s38, s60
  s_addc_u32 s17, s39, 0
  s_mov_b32 s18, 0x20000
  s_mov_b32 s19, 0x00020000
  s_add_u32 s20, s40, s60
  s_addc_u32 s21, s41, 0
  s_mov_b32 s22, 0x20000
  s_mov_b32 s23, 0x00020000
  s_mul_i32 s60, s52, 589824
  s_add_u32 s24, s44, s60
  s_addc_u32 s25, s45, 0
  s_mov_b32 s26, 0x90000
  s_mov_b32 s27, 0x00020000
  s_mov_b32 s32, s46
  s_mov_b32 s33, s47
  s_mov_b32 s34, 0x90000
  s_mov_b32 s35, 0x00020000
  s_mov_b32 s70, s66
  s_xor_b32 s71, s70, 0x10000
  v_mov_b32 v24, 0x26000
  s_lshl_b32 s60, s57, 2
  s_add_u32 s60, s60, 0x26000
  v_mov_b32 v25, s60
  ds_read_b128 v[108:111], v24 offset:16
  s_add_u32 s60, s7, 2
  s_cmp_ge_u32 s60, 9
  s_cselect_b32 s61, 9, 0
  s_sub_u32 s69, s60, s61
  s_lshl_b32 s60, s69, 7
  s_lshr_b32 s61, s66, 1
  s_add_u32 m0, s61, 147456
  s_add_u32 s60, s60, s67
  buffer_load_dwordx4 v4, s[8:11], s60 offen offset:0 lds
  buffer_load_dwordx4 v5, s[8:11], s60 offen offset:1024 lds
  s_lshl_b32 s60, s69, 19
  s_add_u32 m0, s66, 32768
  s_add_u32 s60, s60, s68
  buffer_load_dwordx4 v6, s[12:15], s60 offen offset:0 lds
  buffer_load_dwordx4 v7, s[12:15], s60 offen offset:1024 lds
  buffer_load_dwordx4 v8, s[12:15], s60 offen offset:2048 lds
  buffer_load_dwordx4 v9, s[12:15], s60 offen offset:3072 lds
  s_waitcnt vmcnt(14)
  v_mov_b32 v104, 1
  s_mov_b64 exec, 1
  ds_max_u32 v25, v104
  s_mov_b64 exec, -1
  s_waitcnt lgkmcnt(1)
  v_min3_u32 v108, v108, v109, v110
  v_min_u32 v108, v108, v111
  s_nop 0
  v_readfirstlane_b32 s92, v108
  ds_read_b128 v[108:111], v24 offset:16
  s_add_u32 s60, s7, 3
  s_cmp_ge_u32 s60, 9
  s_cselect_b32 s61, 9, 0
  s_sub_u32 s69, s60, s61
  s_lshl_b32 s60, s69, 7
  s_lshr_b32 s61, s66, 1
  s_add_u32 m0, s61, 114688
  s_add_u32 s60, s60, s67
  buffer_load_dwordx4 v4, s[8:11], s60 offen offset:0 lds
  buffer_load_dwordx4 v5, s[8:11], s60 offen offset:1024 lds
  s_lshl_b32 s60, s69, 19
  s_add_u32 m0, s66, 49152
  s_add_u32 s60, s60, s68
  buffer_load_dwordx4 v6, s[12:15], s60 offen offset:0 lds
  buffer_load_dwordx4 v7, s[12:15], s60 offen offset:1024 lds
  buffer_load_dwordx4 v8, s[12:15], s60 offen offset:2048 lds
  buffer_load_dwordx4 v9, s[12:15], s60 offen offset:3072 lds
  s_waitcnt vmcnt(13)
  v_mov_b32 v104, 2
  s_mov_b64 exec, 1
  ds_max_u32 v25, v104
  s_mov_b64 exec, -1
  s_waitcnt lgkmcnt(1)
  v_min3_u32 v108, v108, v109, v110
  v_min_u32 v108, v108, v111
  s_nop 0
  v_readfirstlane_b32 s92, v108
  ds_read_b128 v[108:111], v24 offset:16
  s_add_u32 s60, s7, 4
  s_cmp_ge_u32 s60, 9
  s_cselect_b32 s61, 9, 0
  s_sub_u32 s69, s60, s61
  s_lshl_b32 s60, s69, 7
  s_lshr_b32 s61, s66, 1
  s_add_u32 m0, s61, 122880
  s_add_u32 s60, s60, s67
  buffer_load_dwordx4 v4, s[8:11], s60 offen offset:0 lds
  buffer_load_dwordx4 v5, s[8:11], s60 offen offset:1024 lds
  s_lshl_b32 s60, s69, 19
  s_add_u32 m0, s66, 65536
  s_add_u32 s60, s60, s68
  buffer_load_dwordx4 v6, s[12:15], s60 offen offset:0 lds
  buffer_load_dwordx4 v7, s[12:15], s60 offen offset:1024 lds
  buffer_load_dwordx4 v8, s[12:15], s60 offen offset:2048 lds
  buffer_load_dwordx4 v9, s[12:15], s60 offen offset:3072 lds
  s_waitcnt vmcnt(12)
  v_mov_b32 v104, 3
  s_mov_b64 exec, 1
  ds_max_u32 v25, v104
  s_mov_b64 exec, -1
  s_waitcnt lgkmcnt(1)
  v_min3_u32 v108, v108, v109, v110
  v_min_u32 v108, v108, v111
  s_nop 0
  v_readfirstlane_b32 s92, v108
  ds_read_b128 v[108:111], v24 offset:16
  s_add_u32 s60, s7, 5
  s_cmp_ge_u32 s60, 9
  s_cselect_b32 s61, 9, 0
  s_sub_u32 s69, s60, s61
  s_lshl_b32 s60, s69, 7
  s_lshr_b32 s61, s66, 1
  s_add_u32 m0, s61, 98304
  s_add_u32 s60, s60, s67
  buffer_load_dwordx4 v4, s[8:11], s60 offen offset:0 lds
  buffer_load_dwordx4 v5, s[8:11], s60 offen offset:1024 lds
  s_lshl_b32 s60, s69, 19
  s_add_u32 m0, s66, 81920
  s_add_u32 s60, s60, s68
  buffer_load_dwordx4 v6, s[12:15], s60 offen offset:0 lds
  buffer_load_dwordx4 v7, s[12:15], s60 offen offset:1024 lds
  buffer_load_dwordx4 v8, s[12:15], s60 offen offset:2048 lds
  buffer_load_dwordx4 v9, s[12:15], s60 offen offset:3072 lds
  s_waitcnt vmcnt(12)
  v_mov_b32 v104, 4
  s_mov_b64 exec, 1
  ds_max_u32 v25, v104
  s_mov_b64 exec, -1
  s_waitcnt lgkmcnt(1)
  v_min3_u32 v108, v108, v109, v110
  v_min_u32 v108, v108, v111
  s_nop 0
  v_readfirstlane_b32 s92, v108
  s_cmp_ge_u32 s92, 1
  s_cbranch_scc1 L_OK83
L_SP84:
  ds_read_b128 v[104:107], v24 offset:16
  s_waitcnt lgkmcnt(0)
  v_min3_u32 v104, v104, v105, v106
  v_min_u32 v104, v104, v107
  s_nop 0
  v_readfirstlane_b32 s92, v104
  s_add_i32 s93, s93, -1
  s_cmp_lt_i32 s93, 0
  s_cbranch_scc1 L_OK83
  s_cmp_ge_u32 s92, 1
  s_cbranch_scc1 L_OK83
  s_sleep 3
  s_branch L_SP84
L_OK83:
  ds_read_b128 v[108:111], v24 offset:16
  s_add_u32 s60, s7, 6
  s_cmp_ge_u32 s60, 9
  s_cselect_b32 s61, 9, 0
  s_sub_u32 s69, s60, s61
  s_lshl_b32 s60, s69, 7
  s_lshr_b32 s61, s66, 1
  s_add_u32 m0, s61, 131072
  s_add_u32 s60, s60, s67
  buffer_load_dwordx4 v4, s[8:11], s60 offen offset:0 lds
  buffer_load_dwordx4 v5, s[8:11], s60 offen offset:1024 lds
  s_lshl_b32 s60, s69, 19
  s_add_u32 m0, s66, 0
  s_add_u32 s60, s60, s68
  buffer_load_dwordx4 v6, s[12:15], s60 offen offset:0 lds
  buffer_load_dwordx4 v7, s[12:15], s60 offen offset:1024 lds
  buffer_load_dwordx4 v8, s[12:15], s60 offen offset:2048 lds
  buffer_load_dwordx4 v9, s[12:15], s60 offen offset:3072 lds
  s_waitcnt vmcnt(12)
  v_mov_b32 v104, 5
  s_mov_b64 exec, 1
  ds_max_u32 v25, v104
  s_mov_b64 exec, -1
  s_waitcnt lgkmcnt(1)
  v_min3_u32 v108, v108, v109, v110
  v_min_u32 v108, v108, v111
  s_nop 0
  v_readfirstlane_b32 s92, v108
  s_cmp_ge_u32 s92, 2
  s_cbranch_scc1 L_OK85
L_SP86:
  ds_read_b128 v[104:107], v24 offset:16
  s_waitcnt lgkmcnt(0)
  v_min3_u32 v104, v104, v105, v106
  v_min_u32 v104, v104, v107
  s_nop 0
  v_readfirstlane_b32 s92, v104
  s_add_i32 s93, s93, -1
  s_cmp_lt_i32 s93, 0
  s_cbranch_scc1 L_OK85
  s_cmp_ge_u32 s92, 2
  s_cbranch_scc1 L_OK85
  s_sleep 3
  s_branch L_SP86
L_OK85:
  ds_read_b128 v[108:111], v24 offset:16
  s_add_u32 s60, s7, 7
  s_cmp_ge_u32 s60, 9
  s_cselect_b32 s61, 9, 0
  s_sub_u32 s69, s60, s61
  s_lshl_b32 s60, s69, 7
  s_lshr_b32 s61, s66, 1
  s_add_u32 m0, s61, 139264
  s_add_u32 s60, s60, s67
  buffer_load_dwordx4 v4, s[8:11], s60 offen offset:0 lds
  buffer_load_dwordx4 v5, s[8:11], s60 offen offset:1024 lds
  s_lshl_b32 s60, s69, 19
  s_add_u32 m0, s66, 16384
  s_add_u32 s60, s60, s68
  buffer_load_dwordx4 v6, s[12:15], s60 offen offset:0 lds
  buffer_load_dwordx4 v7, s[12:15], s60 offen offset:1024 lds
  buffer_load_dwordx4 v8, s[12:15], s60 offen offset:2048 lds
  buffer_load_dwordx4 v9, s[12:15], s60 offen offset:3072 lds
  s_waitcnt vmcnt(12)
  v_mov_b32 v104, 6
  s_mov_b64 exec, 1
  ds_max_u32 v25, v104
  s_mov_b64 exec, -1
  s_waitcnt lgkmcnt(1)
  v_min3_u32 v108, v108, v109, v110
  v_min_u32 v108, v108, v111
  s_nop 0
  v_readfirstlane_b32 s92, v108
  s_cmp_ge_u32 s92, 3
  s_cbranch_scc1 L_OK87
L_SP88:
  ds_read_b128 v[104:107], v24 offset:16
  s_waitcnt lgkmcnt(0)
  v_min3_u32 v104, v104, v105, v106
  v_min_u32 v104, v104, v107
  s_nop 0
  v_readfirstlane_b32 s92, v104
  s_add_i32 s93, s93, -1
  s_cmp_lt_i32 s93, 0
  s_cbranch_scc1 L_OK87
  s_cmp_ge_u32 s92, 3
  s_cbranch_scc1 L_OK87
  s_sleep 3
  s_branch L_SP88
L_OK87:
  ds_read_b128 v[108:111], v24 offset:16
  s_add_u32 s60, s7, 8
  s_cmp_ge_u32 s60, 9
  s_cselect_b32 s61, 9, 0
  s_sub_u32 s69, s60, s61
  s_lshl_b32 s60, s69, 7
  s_lshr_b32 s61, s66, 1
  s_add_u32 m0, s61, 147456
  s_add_u32 s60, s60, s67
  buffer_load_dwordx4 v4, s[8:11], s60 offen offset:0 lds
  buffer_load_dwordx4 v5, s[8:11], s60 offen offset:1024 lds
  s_lshl_b32 s60, s69, 19
  s_add_u32 m0, s66, 32768
  s_add_u32 s60, s60, s68
  buffer_load_dwordx4 v6, s[12:15], s60 offen offset:0 lds
  buffer_load_dwordx4 v7, s[12:15], s60 offen offset:1024 lds
  buffer_load_dwordx4 v8, s[12:15], s60 offen offset:2048 lds
  buffer_load_dwordx4 v9, s[12:15], s60 offen offset:3072 lds
  s_waitcnt vmcnt(12)
  v_mov_b32 v104, 7
  s_mov_b64 exec, 1
  ds_max_u32 v25, v104
  s_mov_b64 exec, -1
  s_waitcnt lgkmcnt(1)
  v_min3_u32 v108, v108, v109, v110
  v_min_u32 v108, v108, v111
  s_nop 0
  v_readfirstlane_b32 s92, v108
  s_cmp_ge_u32 s92, 4
  s_cbranch_scc1 L_OK89
L_SP90:
  ds_read_b128 v[104:107], v24 offset:16
  s_waitcnt lgkmcnt(0)
  v_min3_u32 v104, v104, v105, v106
  v_min_u32 v104, v104, v107
  s_nop 0
  v_readfirstlane_b32 s92, v104
  s_add_i32 s93, s93, -1
  s_cmp_lt_i32 s93, 0
  s_cbranch_scc1 L_OK89
  s_cmp_ge_u32 s92, 4
  s_cbranch_scc1 L_OK89
  s_sleep 3
  s_branch L_SP90
L_OK89:
  ds_read_b128 v[108:111], v24 offset:16
  s_add_u32 m0, s66, 49152
  s_add_u32 s60, s70, 0
  buffer_load_dwordx4 v10, s[16:19], s60 offen offset:0 nt lds
  buffer_load_dwordx4 v11, s[16:19], s60 offen offset:1024 nt lds
  buffer_load_dwordx4 v12, s[16:19], s60 offen offset:2048 nt lds
  buffer_load_dwordx4 v13, s[16:19], s60 offen offset:3072 nt lds
  s_waitcnt vmcnt(4)
  v_mov_b32 v104, 9
  s_mov_b64 exec, 1
  ds_max_u32 v25, v104
  s_mov_b64 exec, -1
  s_waitcnt lgkmcnt(1)
  v_min3_u32 v108, v108, v109, v110
  v_min_u32 v108, v108, v111
  s_nop 0
  v_readfirstlane_b32 s92, v108
  s_cmp_ge_u32 s92, 5
  s_cbranch_scc1 L_OK91
L_SP92:
  ds_read_b128 v[104:107], v24 offset:16
  s_waitcnt lgkmcnt(0)
  v_min3_u32 v104, v104, v105, v106
  v_min_u32 v104, v104, v107
  s_nop 0
  v_readfirstlane_b32 s92, v104
  s_add_i32 s93, s93, -1
  s_cmp_lt_i32 s93, 0
  s_cbranch_scc1 L_OK91
  s_cmp_ge_u32 s92, 5
  s_cbranch_scc1 L_OK91
  s_sleep 3
  s_branch L_SP92
L_OK91:
  ds_read_b128 v[108:111], v24 offset:16
  s_add_u32 m0, s66, 65536
  s_add_u32 s60, s70, 16384
  buffer_load_dwordx4 v10, s[16:19], s60 offen offset:0 nt lds
  buffer_load_dwordx4 v11, s[16:19], s60 offen offset:1024 nt lds
  buffer_load_dwordx4 v12, s[16:19], s60 offen offset:2048 nt lds
  buffer_load_dwordx4 v13, s[16:19], s60 offen offset:3072 nt lds
  s_waitcnt lgkmcnt(0)
  v_min3_u32 v108, v108, v109, v110
  v_min_u32 v108, v108, v111
  s_nop 0
  v_readfirstlane_b32 s92, v108
  ds_read_b128 v[108:111], v24 offset:16
  s_add_u32 m0, s66, 114688
  s_add_u32 s60, s70, 32768
  buffer_load_dwordx4 v10, s[16:19], s60 offen offset:0 nt lds
  buffer_load_dwordx4 v11, s[16:19], s60 offen offset:1024 nt lds
  buffer_load_dwordx4 v12, s[16:19], s60 offen offset:2048 nt lds
  buffer_load_dwordx4 v13, s[16:19], s60 offen offset:3072 nt lds
  s_waitcnt vmcnt(8)
  v_mov_b32 v104, 10
  s_mov_b64 exec, 1
  ds_max_u32 v25, v104
  s_mov_b64 exec, -1
  s_waitcnt lgkmcnt(1)
  v_min3_u32 v108, v108, v109, v110
  v_min_u32 v108, v108, v111
  s_nop 0
  v_readfirstlane_b32 s92, v108
  s_cmp_ge_u32 s92, 6
  s_cbranch_scc1 L_OK93
L_SP94:
  ds_read_b128 v[104:107], v24 offset:16
  s_waitcnt lgkmcnt(0)
  v_min3_u32 v104, v104, v105, v106
  v_min_u32 v104, v104, v107
  s_nop 0
  v_readfirstlane_b32 s92, v104
  s_add_i32 s93, s93, -1
  s_cmp_lt_i32 s93, 0
  s_cbranch_scc1 L_OK93
  s_cmp_ge_u32 s92, 6
  s_cbranch_scc1 L_OK93
  s_sleep 3
  s_branch L_SP94
L_OK93:
  ds_read_b128 v[108:111], v24 offset:16
  s_add_u32 m0, s66, 81920
  s_add_u32 s60, s70, 49152
  buffer_load_dwordx4 v10, s[16:19], s60 offen offset:0 nt lds
  buffer_load_dwordx4 v11, s[16:19], s60 offen offset:1024 nt lds
  buffer_load_dwordx4 v12, s[16:19], s60 offen offset:2048 nt lds
  buffer_load_dwordx4 v13, s[16:19], s60 offen offset:3072 nt lds
  s_waitcnt vmcnt(8)
  v_mov_b32 v104, 11
  s_mov_b64 exec, 1
  ds_max_u32 v25, v104
  s_mov_b64 exec, -1
  s_waitcnt lgkmcnt(1)
  v_min3_u32 v108, v108, v109, v110
  v_min_u32 v108, v108, v111
  s_nop 0
  v_readfirstlane_b32 s92, v108
  ds_read_b128 v[108:111], v24 offset:16
  s_add_u32 m0, s66, 98304
  s_add_u32 s60, s71, 0
  buffer_load_dwordx4 v10, s[16:19], s60 offen offset:0 nt lds
  buffer_load_dwordx4 v11, s[16:19], s60 offen offset:1024 nt lds
  buffer_load_dwordx4 v12, s[16:19], s60 offen offset:2048 nt lds
  buffer_load_dwordx4 v13, s[16:19], s60 offen offset:3072 nt lds
  s_waitcnt vmcnt(8)
  v_mov_b32 v104, 12
  s_mov_b64 exec, 1
  ds_max_u32 v25, v104
  s_mov_b64 exec, -1
  s_waitcnt lgkmcnt(1)
  v_min3_u32 v108, v108, v109, v110
  v_min_u32 v108, v108, v111
  s_nop 0
  v_readfirstlane_b32 s92, v108
  s_cmp_ge_u32 s92, 7
  s_cbranch_scc1 L_OK95
L_SP96:
  ds_read_b128 v[104:107], v24 offset:16
  s_waitcnt lgkmcnt(0)
  v_min3_u32 v104, v104, v105, v106
  v_min_u32 v104, v104, v107
  s_nop 0
  v_readfirstlane_b32 s92, v104
  s_add_i32 s93, s93, -1
  s_cmp_lt_i32 s93, 0
  s_cbranch_scc1 L_OK95
  s_cmp_ge_u32 s92, 7
  s_cbranch_scc1 L_OK95
  s_sleep 3
  s_branch L_SP96
L_OK95:
  ds_read_b128 v[108:111], v24 offset:16
  s_add_u32 m0, s66, 0
  s_add_u32 s60, s71, 16384
  buffer_load_dwordx4 v10, s[16:19], s60 offen offset:0 nt lds
  buffer_load_dwordx4 v11, s[16:19], s60 offen offset:1024 nt lds
  buffer_load_dwordx4 v12, s[16:19], s60 offen offset:2048 nt lds
  buffer_load_dwordx4 v13, s[16:19], s60 offen offset:3072 nt lds
  s_waitcnt vmcnt(8)
  v_mov_b32 v104, 13
  s_mov_b64 exec, 1
  ds_max_u32 v25, v104
  s_mov_b64 exec, -1
  s_waitcnt lgkmcnt(1)
  v_min3_u32 v108, v108, v109, v110
  v_min_u32 v108, v108, v111
  s_nop 0
  v_readfirstlane_b32 s92, v108
  s_cmp_ge_u32 s92, 9
  s_cbranch_scc1 L_OK97
L_SP98:
  ds_read_b128 v[104:107], v24 offset:16
  s_waitcnt lgkmcnt(0)
  v_min3_u32 v104, v104, v105, v106
  v_min_u32 v104, v104, v107
  s_nop 0
  v_readfirstlane_b32 s92, v104
  s_add_i32 s93, s93, -1
  s_cmp_lt_i32 s93, 0
  s_cbranch_scc1 L_OK97
  s_cmp_ge_u32 s92, 9
  s_cbranch_scc1 L_OK97
  s_sleep 3
  s_branch L_SP98
L_OK97:
  ds_read_b128 v[108:111], v24 offset:16
  s_add_u32 m0, s66, 32768
  s_add_u32 s60, s71, 32768
  buffer_load_dwordx4 v10, s[16:19], s60 offen offset:0 nt lds
  buffer_load_dwordx4 v11, s[16:19], s60 offen offset:1024 nt lds
  buffer_load_dwordx4 v12, s[16:19], s60 offen offset:2048 nt lds
  buffer_load_dwordx4 v13, s[16:19], s60 offen offset:3072 nt lds
  s_waitcnt vmcnt(8)
  v_mov_b32 v104, 14
  s_mov_b64 exec, 1
  ds_max_u32 v25, v104
  s_mov_b64 exec, -1
  s_waitcnt lgkmcnt(1)
  v_min3_u32 v108, v108, v109, v110
  v_min_u32 v108, v108, v111
  s_nop 0
  v_readfirstlane_b32 s92, v108
  ds_read_b128 v[108:111], v24 offset:16
  s_add_u32 m0, s66, 131072
  s_add_u32 s60, s71, 49152
  buffer_load_dwordx4 v10, s[16:19], s60 offen offset:0 nt lds
  buffer_load_dwordx4 v11, s[16:19], s60 offen offset:1024 nt lds
  buffer_load_dwordx4 v12, s[16:19], s60 offen offset:2048 nt lds
  buffer_load_dwordx4 v13, s[16:19], s60 offen offset:3072 nt lds
  s_waitcnt vmcnt(8)
  v_mov_b32 v104, 15
  s_mov_b64 exec, 1
  ds_max_u32 v25, v104
  s_mov_b64 exec, -1
  s_waitcnt lgkmcnt(1)
  v_min3_u32 v108, v108, v109, v110
  v_min_u32 v108, v108, v111
  s_nop 0
  v_readfirstlane_b32 s92, v108
  s_cmp_ge_u32 s92, 10
  s_cbranch_scc1 L_OK99
L_SP100:
  ds_read_b128 v[104:107], v24 offset:16
  s_waitcnt lgkmcnt(0)
  v_min3_u32 v104, v104, v105, v106
  v_min_u32 v104, v104, v107
  s_nop 0
  v_readfirstlane_b32 s92, v104
  s_add_i32 s93, s93, -1
  s_cmp_lt_i32 s93, 0
  s_cbranch_scc1 L_OK99
  s_cmp_ge_u32 s92, 10
  s_cbranch_scc1 L_OK99
  s_sleep 3
  s_branch L_SP100
L_OK99:
  ds_read_b128 v[108:111], v24 offset:16
  s_add_u32 m0, s66, 16384
  s_add_u32 s60, s70, 0
  buffer_load_dwordx4 v14, s[20:23], s60 offen offset:0 nt lds
  buffer_load_dwordx4 v14, s[20:23], s60 offen offset:1024 nt lds
  buffer_load_dwordx4 v14, s[20:23], s60 offen offset:2048 nt lds
  buffer_load_dwordx4 v14, s[20:23], s60 offen offset:3072 nt lds
  s_waitcnt vmcnt(4)
  v_mov_b32 v104, 17
  s_mov_b64 exec, 1
  ds_max_u32 v25, v104
  s_mov_b64 exec, -1
  s_waitcnt lgkmcnt(1)
  v_min3_u32 v108, v108, v109, v110
  v_min_u32 v108, v108, v111
  s_nop 0
  v_readfirstlane_b32 s92, v108
  v_readfirstlane_b32 s58, v39
  s_nop 0
  s_add_u32 s58, s58, 1
  s_cmp_ge_u32 s92, 11
  s_cbranch_scc1 L_OK101
L_SP102:
  ds_read_b128 v[104:107], v24 offset:16
  s_waitcnt lgkmcnt(0)
  v_min3_u32 v104, v104, v105, v106
  v_min_u32 v104, v104, v107
  s_nop 0
  v_readfirstlane_b32 s92, v104
  s_add_i32 s93, s93, -1
  s_cmp_lt_i32 s93, 0
  s_cbranch_scc1 L_OK101
  s_cmp_ge_u32 s92, 11
  s_cbranch_scc1 L_OK101
  s_sleep 3
  s_branch L_SP102
L_OK101:
  ds_read_b128 v[108:111], v24 offset:16
  s_add_u32 m0, s66, 49152
  s_add_u32 s60, s70, 16384
  buffer_load_dwordx4 v14, s[20:23], s60 offen offset:0 nt lds
  buffer_load_dwordx4 v14, s[20:23], s60 offen offset:1024 nt lds
  buffer_load_dwordx4 v14, s[20:23], s60 offen offset:2048 nt lds
  buffer_load_dwordx4 v14, s[20:23], s60 offen offset:3072 nt lds
  s_waitcnt lgkmcnt(0)
  v_min3_u32 v108, v108, v109, v110
  v_min_u32 v108, v108, v111
  s_nop 0
  v_readfirstlane_b32 s92, v108
  s_cmp_ge_u32 s92, 12
  s_cbranch_scc1 L_OK103
L_SP104:
  ds_read_b128 v[104:107], v24 offset:16
  s_waitcnt lgkmcnt(0)
  v_min3_u32 v104, v104, v105, v106
  v_min_u32 v104, v104, v107
  s_nop 0
  v_readfirstlane_b32 s92, v104
  s_add_i32 s93, s93, -1
  s_cmp_lt_i32 s93, 0
  s_cbranch_scc1 L_OK103
  s_cmp_ge_u32 s92, 12
  s_cbranch_scc1 L_OK103
  s_sleep 3
  s_branch L_SP104
L_OK103:
  ds_read_b128 v[108:111], v24 offset:16
  s_add_u32 m0, s66, 65536
  s_add_u32 s60, s70, 32768
  buffer_load_dwordx4 v14, s[20:23], s60 offen offset:0 nt lds
  buffer_load_dwordx4 v14, s[20:23], s60 offen offset:1024 nt lds
  buffer_load_dwordx4 v14, s[20:23], s60 offen offset:2048 nt lds
  buffer_load_dwordx4 v14, s[20:23], s60 offen offset:3072 nt lds
  s_waitcnt vmcnt(8)
  v_mov_b32 v104, 18
  s_mov_b64 exec, 1
  ds_max_u32 v25, v104
  s_mov_b64 exec, -1
  s_waitcnt lgkmcnt(1)
  v_min3_u32 v108, v108, v109, v110
  v_min_u32 v108, v108, v111
  s_nop 0
  v_readfirstlane_b32 s92, v108
  s_cmp_ge_u32 s92, 13
  s_cbranch_scc1 L_OK105
L_SP106:
  ds_read_b128 v[104:107], v24 offset:16
  s_waitcnt lgkmcnt(0)
  v_min3_u32 v104, v104, v105, v106
  v_min_u32 v104, v104, v107
  s_nop 0
  v_readfirstlane_b32 s92, v104
  s_add_i32 s93, s93, -1
  s_cmp_lt_i32 s93, 0
  s_cbranch_scc1 L_OK105
  s_cmp_ge_u32 s92, 13
  s_cbranch_scc1 L_OK105
  s_sleep 3
  s_branch L_SP106
L_OK105:
  ds_read_b128 v[108:111], v24 offset:16
  s_add_u32 m0, s66, 114688
  s_add_u32 s60, s70, 49152
  buffer_load_dwordx4 v14, s[20:23], s60 offen offset:0 nt lds
  buffer_load_dwordx4 v14, s[20:23], s60 offen offset:1024 nt lds
  buffer_load_dwordx4 v14, s[20:23], s60 offen offset:2048 nt lds
  buffer_load_dwordx4 v14, s[20:23], s60 offen offset:3072 nt lds
  s_waitcnt vmcnt(8)
  v_mov_b32 v104, 19
  s_mov_b64 exec, 1
  ds_max_u32 v25, v104
  s_mov_b64 exec, -1
  s_waitcnt lgkmcnt(1)
  v_min3_u32 v108, v108, v109, v110
  v_min_u32 v108, v108, v111
  s_nop 0
  v_readfirstlane_b32 s92, v108
  s_cmp_ge_u32 s92, 14
  s_cbranch_scc1 L_OK107
L_SP108:
  ds_read_b128 v[104:107], v24 offset:16
  s_waitcnt lgkmcnt(0)
  v_min3_u32 v104, v104, v105, v106
  v_min_u32 v104, v104, v107
  s_nop 0
  v_readfirstlane_b32 s92, v104
  s_add_i32 s93, s93, -1
  s_cmp_lt_i32 s93, 0
  s_cbranch_scc1 L_OK107
  s_cmp_ge_u32 s92, 14
  s_cbranch_scc1 L_OK107
  s_sleep 3
  s_branch L_SP108
L_OK107:
  ds_read_b128 v[108:111], v24 offset:16
  s_add_u32 m0, s66, 81920
  s_add_u32 s60, s71, 0
  buffer_load_dwordx4 v14, s[20:23], s60 offen offset:0 nt lds
  buffer_load_dwordx4 v14, s[20:23], s60 offen offset:1024 nt lds
  buffer_load_dwordx4 v14, s[20:23], s60 offen offset:2048 nt lds
  buffer_load_dwordx4 v14, s[20:23], s60 offen offset:3072 nt lds
  s_waitcnt vmcnt(8)
  v_mov_b32 v104, 20
  s_mov_b64 exec, 1
  ds_max_u32 v25, v104
  s_mov_b64 exec, -1
  s_waitcnt lgkmcnt(1)
  v_min3_u32 v108, v108, v109, v110
  v_min_u32 v108, v108, v111
  s_nop 0
  v_readfirstlane_b32 s92, v108
  s_cmp_ge_u32 s92, 15
  s_cbranch_scc1 L_OK109
L_SP110:
  ds_read_b128 v[104:107], v24 offset:16
  s_waitcnt lgkmcnt(0)
  v_min3_u32 v104, v104, v105, v106
  v_min_u32 v104, v104, v107
  s_nop 0
  v_readfirstlane_b32 s92, v104
  s_add_i32 s93, s93, -1
  s_cmp_lt_i32 s93, 0
  s_cbranch_scc1 L_OK109
  s_cmp_ge_u32 s92, 15
  s_cbranch_scc1 L_OK109
  s_sleep 3
  s_branch L_SP110
L_OK109:
  ds_read_b128 v[108:111], v24 offset:16
  s_add_u32 m0, s66, 98304
  s_add_u32 s60, s71, 16384
  buffer_load_dwordx4 v14, s[20:23], s60 offen offset:0 nt lds
  buffer_load_dwordx4 v14, s[20:23], s60 offen offset:1024 nt lds
  buffer_load_dwordx4 v14, s[20:23], s60 offen offset:2048 nt lds
  buffer_load_dwordx4 v14, s[20:23], s60 offen offset:3072 nt lds
  s_waitcnt vmcnt(8)
  v_mov_b32 v104, 21
  s_mov_b64 exec, 1
  ds_max_u32 v25, v104
  s_mov_b64 exec, -1
  s_waitcnt lgkmcnt(1)
  v_min3_u32 v108, v108, v109, v110
  v_min_u32 v108, v108, v111
  s_nop 0
  v_readfirstlane_b32 s92, v108
  s_cmp_ge_u32 s92, 16
  s_cbranch_scc1 L_OK111
L_SP112:
  ds_read_b128 v[104:107], v24 offset:16
  s_waitcnt lgkmcnt(0)
  v_min3_u32 v104, v104, v105, v106
  v_min_u32 v104, v104, v107
  s_nop 0
  v_readfirstlane_b32 s92, v104
  s_add_i32 s93, s93, -1
  s_cmp_lt_i32 s93, 0
  s_cbranch_scc1 L_OK111
  s_cmp_ge_u32 s92, 16
  s_cbranch_scc1 L_OK111
  s_sleep 3
  s_branch L_SP112
L_OK111:
  ds_read_b128 v[108:111], v24 offset:16
  s_add_u32 m0, s66, 0
  s_add_u32 s60, s71, 32768
  buffer_load_dwordx4 v14, s[20:23], s60 offen offset:0 nt lds
  buffer_load_dwordx4 v14, s[20:23], s60 offen offset:1024 nt lds
  buffer_load_dwordx4 v14, s[20:23], s60 offen offset:2048 nt lds
  buffer_load_dwordx4 v14, s[20:23], s60 offen offset:3072 nt lds
  s_waitcnt vmcnt(8)
  v_mov_b32 v104, 22
  s_mov_b64 exec, 1
  ds_max_u32 v25, v104
  s_mov_b64 exec, -1
  s_waitcnt lgkmcnt(1)
  v_min3_u32 v108, v108, v109, v110
  v_min_u32 v108, v108, v111
  s_nop 0
  v_readfirstlane_b32 s92, v108
  s_cmp_ge_u32 s92, 17
  s_cbranch_scc1 L_OK113
L_SP114:
  ds_read_b128 v[104:107], v24 offset:16
  s_waitcnt lgkmcnt(0)
  v_min3_u32 v104, v104, v105, v106
  v_min_u32 v104, v104, v107
  s_nop 0
  v_readfirstlane_b32 s92, v104
  s_add_i32 s93, s93, -1
  s_cmp_lt_i32 s93, 0
  s_cbranch_scc1 L_OK113
  s_cmp_ge_u32 s92, 17
  s_cbranch_scc1 L_OK113
  s_sleep 3
  s_branch L_SP114
L_OK113:
  ds_read_b128 v[108:111], v24 offset:16
  s_add_u32 m0, s66, 32768
  s_add_u32 s60, s71, 49152
  buffer_load_dwordx4 v14, s[20:23], s60 offen offset:0 nt lds
  buffer_load_dwordx4 v14, s[20:23], s60 offen offset:1024 nt lds
  buffer_load_dwordx4 v14, s[20:23], s60 offen offset:2048 nt lds
  buffer_load_dwordx4 v14, s[20:23], s60 offen offset:3072 nt lds
  s_waitcnt vmcnt(8)
  v_mov_b32 v104, 23
  s_mov_b64 exec, 1
  ds_max_u32 v25, v104
  s_mov_b64 exec, -1
  s_waitcnt lgkmcnt(1)
  v_min3_u32 v108, v108, v109, v110
  v_min_u32 v108, v108, v111
  s_nop 0
  v_readfirstlane_b32 s92, v108
  v_lshlrev_b32 v43, 2, v1
  s_add_u32 s60, s53, 1
  s_and_b32 s60, s60, 3
  s_lshl_b32 s60, s60, 3
  s_andn2_b32 s61, s59, 0x18
  s_or_b32 s60, s60, s61
  s_lshl_b32 s61, s60, 2
  s_add_u32 s61, s61, s57
  s_lshl_b32 s61, s61, 8
  s_add_u32 s4, s61, 0x10000
  s_mul_i32 s60, s60, 16384
  s_add_u32 s60, s60, s66
  s_add_u32 s68, s60, 0x100000
  s_add_u32 s60, s53, 2
  s_and_b32 s60, s60, 3
  s_lshl_b32 s60, s60, 3
  s_andn2_b32 s61, s59, 0x18
  s_or_b32 s60, s60, s61
  s_lshl_b32 s61, s60, 2
  s_add_u32 s61, s61, s57
  s_lshl_b32 s61, s61, 8
  s_add_u32 s5, s61, 0x10000
  s_mul_i32 s60, s60, 16384
  s_add_u32 s60, s60, s66
  s_add_u32 s70, s60, 0x100000
  s_add_u32 s60, s53, 3
  s_and_b32 s60, s60, 3
  s_lshl_b32 s60, s60, 3
  s_andn2_b32 s61, s59, 0x18
  s_or_b32 s60, s60, s61
  s_lshl_b32 s61, s60, 2
  s_add_u32 s61, s61, s57
  s_lshl_b32 s61, s61, 8
  s_add_u32 s6, s61, 0x10000
  s_mul_i32 s60, s60, 16384
  s_add_u32 s60, s60, s66
  s_add_u32 s71, s60, 0x100000
  ds_read_b128 v[108:111], v24 offset:16
  s_lshl_b32 s60, s54, 2
  s_add_u32 s60, s60, s53
  s_lshl_b32 s60, s60, 2
  s_add_u32 s60, s60, s57
  s_mul_i32 s60, s60, 4608
  v_lshlrev_b32 v40, 7, v1
  s_mov_b32 exec_lo, -1
  s_mov_b32 exec_hi, 0xf
  buffer_load_dword v41, v40, s[24:27], s60 offen
  s_mov_b64 exec, -1
  s_waitcnt vmcnt(1)
  v_mov_b32 v104, 25
  s_mov_b64 exec, 1
  ds_max_u32 v25, v104
  s_mov_b64 exec, -1
  s_waitcnt lgkmcnt(1)
  v_min3_u32 v108, v108, v109, v110
  v_min_u32 v108, v108, v111
  s_nop 0
  v_readfirstlane_b32 s92, v108
  s_cmp_ge_u32 s92, 18
  s_cbranch_scc1 L_OK115
L_SP116:
  ds_read_b128 v[104:107], v24 offset:16
  s_waitcnt lgkmcnt(0)
  v_min3_u32 v104, v104, v105, v106
  v_min_u32 v104, v104, v107
  s_nop 0
  v_readfirstlane_b32 s92, v104
  s_add_i32 s93, s93, -1
  s_cmp_lt_i32 s93, 0
  s_cbranch_scc1 L_OK115
  s_cmp_ge_u32 s92, 18
  s_cbranch_scc1 L_OK115
  s_sleep 3
  s_branch L_SP116
L_OK115:
  ds_read_b128 v[108:111], v24 offset:16
  s_add_u32 s60, s57, s53
  s_and_b32 s60, s60, 3
  s_mul_i32 s60, s60, 147456
  s_lshl_b32 s61, s53, 5
  s_add_u32 s60, s60, s61
  s_add_u32 m0, s66, 131072
  s_add_u32 s60, s60, 1024
  buffer_load_dwordx4 v19, s[24:27], s60 offen offset:0 lds
  buffer_load_dwordx4 v20, s[24:27], s60 offen offset:1024 lds
  buffer_load_dwordx4 v21, s[24:27], s60 offen offset:2048 lds
  buffer_load_dwordx4 v22, s[24:27], s60 offen offset:3072 lds
  s_waitcnt lgkmcnt(0)
  v_min3_u32 v108, v108, v109, v110
  v_min_u32 v108, v108, v111
  s_nop 0
  v_readfirstlane_b32 s92, v108
  s_cmp_ge_u32 s92, 19
  s_cbranch_scc1 L_OK117
L_SP118:
  ds_read_b128 v[104:107], v24 offset:16
  s_waitcnt lgkmcnt(0)
  v_min3_u32 v104, v104, v105, v106
  v_min_u32 v104, v104, v107
  s_nop 0
  v_readfirstlane_b32 s92, v104
  s_add_i32 s93, s93, -1
  s_cmp_lt_i32 s93, 0
  s_cbranch_scc1 L_OK117
  s_cmp_ge_u32 s92, 19
  s_cbranch_scc1 L_OK117
  s_sleep 3
  s_branch L_SP118
L_OK117:
  ds_read_b128 v[108:111], v24 offset:16
  s_lshl_b32 s60, s53, 1
  s_add_u32 s60, s60, 0
  s_and_b32 s60, s60, 7
  s_mul_i32 s60, s60, 73728
  s_add_u32 s60, s60, s67
  s_lshl_b32 s61, s53, 8
  s_add_u32 m0, s66, 16384
  s_add_u32 s60, s60, s61
  buffer_load_dwordx4 v15, s[24:27], s60 offen offset:0 lds
  buffer_load_dwordx4 v16, s[24:27], s60 offen offset:1024 lds
  buffer_load_dwordx4 v17, s[24:27], s60 offen offset:2048 lds
  buffer_load_dwordx4 v18, s[24:27], s60 offen offset:3072 lds
  s_waitcnt vmcnt(8)
  v_mov_b32 v104, 26
  s_mov_b64 exec, 1
  ds_max_u32 v25, v104
  s_mov_b64 exec, -1
  s_waitcnt lgkmcnt(1)
  v_min3_u32 v108, v108, v109, v110
  v_min_u32 v108, v108, v111
  s_nop 0
  v_readfirstlane_b32 s92, v108
  s_cmp_ge_u32 s92, 20
  s_cbranch_scc1 L_OK119
L_SP120:
  ds_read_b128 v[104:107], v24 offset:16
  s_waitcnt lgkmcnt(0)
  v_min3_u32 v104, v104, v105, v106
  v_min_u32 v104, v104, v107
  s_nop 0
  v_readfirstlane_b32 s92, v104
  s_add_i32 s93, s93, -1
  s_cmp_lt_i32 s93, 0
  s_cbranch_scc1 L_OK119
  s_cmp_ge_u32 s92, 20
  s_cbranch_scc1 L_OK119
  s_sleep 3
  s_branch L_SP120
L_OK119:
  ds_read_b128 v[108:111], v24 offset:16
  s_lshl_b32 s60, s53, 1
  s_add_u32 s60, s60, 1
  s_and_b32 s60, s60, 7
  s_mul_i32 s60, s60, 73728
  s_add_u32 s60, s60, s67
  s_lshl_b32 s61, s53, 8
  s_add_u32 m0, s66, 49152
  s_add_u32 s60, s60, s61
  buffer_load_dwordx4 v15, s[24:27], s60 offen offset:0 lds
  buffer_load_dwordx4 v16, s[24:27], s60 offen offset:1024 lds
  buffer_load_dwordx4 v17, s[24:27], s60 offen offset:2048 lds
  buffer_load_dwordx4 v18, s[24:27], s60 offen offset:3072 lds
  s_waitcnt vmcnt(8)
  v_mov_b32 v104, 27
  s_mov_b64 exec, 1
  ds_max_u32 v25, v104
  s_mov_b64 exec, -1
  s_waitcnt lgkmcnt(1)
  v_min3_u32 v108, v108, v109, v110
  v_min_u32 v108, v108, v111
  s_nop 0
  v_readfirstlane_b32 s92, v108
  s_cmp_ge_u32 s92, 21
  s_cbranch_scc1 L_OK121
L_SP122:
  ds_read_b128 v[104:107], v24 offset:16
  s_waitcnt lgkmcnt(0)
  v_min3_u32 v104, v104, v105, v106
  v_min_u32 v104, v104, v107
  s_nop 0
  v_readfirstlane_b32 s92, v104
  s_add_i32 s93, s93, -1
  s_cmp_lt_i32 s93, 0
  s_cbranch_scc1 L_OK121
  s_cmp_ge_u32 s92, 21
  s_cbranch_scc1 L_OK121
  s_sleep 3
  s_branch L_SP122
L_OK121:
  ds_read_b128 v[108:111], v24 offset:16
  s_lshl_b32 s60, s53, 1
  s_add_u32 s60, s60, 2
  s_and_b32 s60, s60, 7
  s_mul_i32 s60, s60, 73728
  s_add_u32 s60, s60, s67
  s_lshl_b32 s61, s53, 8
  s_add_u32 m0, s66, 65536
  s_add_u32 s60, s60, s61
  buffer_load_dwordx4 v15, s[24:27], s60 offen offset:0 lds
  buffer_load_dwordx4 v16, s[24:27], s60 offen offset:1024 lds
  buffer_load_dwordx4 v17, s[24:27], s60 offen offset:2048 lds
  buffer_load_dwordx4 v18, s[24:27], s60 offen offset:3072 lds
  s_waitcnt vmcnt(8)
  v_mov_b32 v104, 28
  s_mov_b64 exec, 1
  ds_max_u32 v25, v104
  s_mov_b64 exec, -1
  s_waitcnt lgkmcnt(1)
  v_min3_u32 v108, v108, v109, v110
  v_min_u32 v108, v108, v111
  s_nop 0
  v_readfirstlane_b32 s92, v108
  s_cmp_ge_u32 s92, 25
  s_cbranch_scc1 L_OK123
L_SP124:
  ds_read_b128 v[104:107], v24 offset:16
  s_waitcnt lgkmcnt(0)
  v_min3_u32 v104, v104, v105, v106
  v_min_u32 v104, v104, v107
  s_nop 0
  v_readfirstlane_b32 s92, v104
  s_add_i32 s93, s93, -1
  s_cmp_lt_i32 s93, 0
  s_cbranch_scc1 L_OK123
  s_cmp_ge_u32 s92, 25
  s_cbranch_scc1 L_OK123
  s_sleep 3
  s_branch L_SP124
L_OK123:
  ds_read_b128 v[108:111], v24 offset:16
  s_lshl_b32 s60, s53, 1
  s_add_u32 s60, s60, 3
  s_and_b32 s60, s60, 7
  s_mul_i32 s60, s60, 73728
  s_add_u32 s60, s60, s67
  s_lshl_b32 s61, s53, 8
  s_add_u32 m0, s66, 0
  s_add_u32 s60, s60, s61
  buffer_load_dwordx4 v15, s[24:27], s60 offen offset:0 lds
  buffer_load_dwordx4 v16, s[24:27], s60 offen offset:1024 lds
  buffer_load_dwordx4 v17, s[24:27], s60 offen offset:2048 lds
  buffer_load_dwordx4 v18, s[24:27], s60 offen offset:3072 lds
  s_waitcnt vmcnt(8)
  v_mov_b32 v104, 29
  s_mov_b64 exec, 1
  ds_max_u32 v25, v104
  s_mov_b64 exec, -1
  s_waitcnt lgkmcnt(1)
  v_min3_u32 v108, v108, v109, v110
  v_min_u32 v108, v108, v111
  s_nop 0
  v_readfirstlane_b32 s92, v108
  s_cmp_ge_u32 s92, 28
  s_cbranch_scc1 L_OK125
L_SP126:
  ds_read_b128 v[104:107], v24 offset:16
  s_waitcnt lgkmcnt(0)
  v_min3_u32 v104, v104, v105, v106
  v_min_u32 v104, v104, v107
  s_nop 0
  v_readfirstlane_b32 s92, v104
  s_add_i32 s93, s93, -1
  s_cmp_lt_i32 s93, 0
  s_cbranch_scc1 L_OK125
  s_cmp_ge_u32 s92, 28
  s_cbranch_scc1 L_OK125
  s_sleep 3
  s_branch L_SP126
L_OK125:
  ds_read_b128 v[108:111], v24 offset:16
  s_lshl_b32 s60, s53, 1
  s_add_u32 s60, s60, 4
  s_and_b32 s60, s60, 7
  s_mul_i32 s60, s60, 73728
  s_add_u32 s60, s60, s67
  s_lshl_b32 s61, s53, 8
  s_add_u32 m0, s66, 16384
  s_add_u32 s60, s60, s61
  buffer_load_dwordx4 v15, s[24:27], s60 offen offset:0 lds
  buffer_load_dwordx4 v16, s[24:27], s60 offen offset:1024 lds
  buffer_load_dwordx4 v17, s[24:27], s60 offen offset:2048 lds
  buffer_load_dwordx4 v18, s[24:27], s60 offen offset:3072 lds
  s_waitcnt vmcnt(8)
  v_mov_b32 v104, 30
  s_mov_b64 exec, 1
  ds_max_u32 v25, v104
  s_mov_b64 exec, -1
  s_waitcnt lgkmcnt(1)
  v_min3_u32 v108, v108, v109, v110
  v_min_u32 v108, v108, v111
  s_nop 0
  v_readfirstlane_b32 s92, v108
  s_cmp_ge_u32 s92, 29
  s_cbranch_scc1 L_OK127
L_SP128:
  ds_read_b128 v[104:107], v24 offset:16
  s_waitcnt lgkmcnt(0)
  v_min3_u32 v104, v104, v105, v106
  v_min_u32 v104, v104, v107
  s_nop 0
  v_readfirstlane_b32 s92, v104
  s_add_i32 s93, s93, -1
  s_cmp_lt_i32 s93, 0
  s_cbranch_scc1 L_OK127
  s_cmp_ge_u32 s92, 29
  s_cbranch_scc1 L_OK127
  s_sleep 3
  s_branch L_SP128
L_OK127:
  ds_read_b128 v[108:111], v24 offset:16
  s_lshl_b32 s60, s53, 1
  s_add_u32 s60, s60, 5
  s_and_b32 s60, s60, 7
  s_mul_i32 s60, s60, 73728
  s_add_u32 s60, s60, s67
  s_lshl_b32 s61, s53, 8
  s_add_u32 m0, s66, 49152
  s_add_u32 s60, s60, s61
  buffer_load_dwordx4 v15, s[24:27], s60 offen offset:0 lds
  buffer_load_dwordx4 v16, s[24:27], s60 offen offset:1024 lds
  buffer_load_dwordx4 v17, s[24:27], s60 offen offset:2048 lds
  buffer_load_dwordx4 v18, s[24:27], s60 offen offset:3072 lds
  s_waitcnt vmcnt(8)
  v_mov_b32 v104, 31
  s_mov_b64 exec, 1
  ds_max_u32 v25, v104
  s_mov_b64 exec, -1
  s_waitcnt lgkmcnt(1)
  v_min3_u32 v108, v108, v109, v110
  v_min_u32 v108, v108, v111
  s_nop 0
  v_readfirstlane_b32 s92, v108
  s_waitcnt vmcnt(0)
  v_mov_b32 v104, 33
  s_mov_b64 exec, 1
  ds_max_u32 v25, v104
  s_mov_b64 exec, -1
  s_add_u32 m0, s66, 32768
  s_nop 0
  buffer_load_dwordx4 v23, s[28:31], s68 offen offset:0 sc1 lds
  buffer_load_dwordx4 v23, s[28:31], s68 offen offset:1024 sc1 lds
  buffer_load_dwordx4 v23, s[28:31], s68 offen offset:2048 sc1 lds
  buffer_load_dwordx4 v23, s[28:31], s68 offen offset:3072 sc1 lds
  buffer_load_dword v45, v43, s[28:31], s4 offen sc1
  s_add_u32 m0, s66, 81920
  s_nop 0
  buffer_load_dwordx4 v23, s[28:31], s70 offen offset:0 sc1 lds
  buffer_load_dwordx4 v23, s[28:31], s70 offen offset:1024 sc1 lds
  buffer_load_dwordx4 v23, s[28:31], s70 offen offset:2048 sc1 lds
  buffer_load_dwordx4 v23, s[28:31], s70 offen offset:3072 sc1 lds
  buffer_load_dword v46, v43, s[28:31], s5 offen sc1
  s_add_u32 m0, s66, 98304
  s_nop 0
  buffer_load_dwordx4 v23, s[28:31], s71 offen offset:0 sc1 lds
  buffer_load_dwordx4 v23, s[28:31], s71 offen offset:1024 sc1 lds
  buffer_load_dwordx4 v23, s[28:31], s71 offen offset:2048 sc1 lds
  buffer_load_dwordx4 v23, s[28:31], s71 offen offset:3072 sc1 lds
  buffer_load_dword v47, v43, s[28:31], s6 offen sc1
  s_mov_b32 s63, 0
  s_waitcnt vmcnt(10)
L_VER1:
  v_add_u32 v42, s66, v23
  v_add_u32 v42, 0x8000, v42
  ds_read_b128 v[48:51], v42 offset:0
  ds_read_b128 v[52:55], v42 offset:1024
  ds_read_b128 v[56:59], v42 offset:2048
  ds_read_b128 v[60:63], v42 offset:3072
  s_waitcnt lgkmcnt(0)
  v_xor_b32 v42, s58, v45
  v_xor_b32 v42, v48, v42
  v_xor_b32 v42, v49, v42
  v_xor_b32 v42, v50, v42
  v_xor_b32 v42, v51, v42
  v_xor_b32 v42, v52, v42
  v_xor_b32 v42, v53, v42
  v_xor_b32 v42, v54, v42
  v_xor_b32 v42, v55, v42
  v_xor_b32 v42, v56, v42
  v_xor_b32 v42, v57, v42
  v_xor_b32 v42, v58, v42
  v_xor_b32 v42, v59, v42
  v_xor_b32 v42, v60, v42
  v_xor_b32 v42, v61, v42
  v_xor_b32 v42, v62, v42
  v_xor_b32 v42, v63, v42
  v_cmp_ne_u32 vcc, 0, v42
  s_add_u32 s63, s63, 1
  s_cmp_gt_u32 s63, 40000
  s_cbranch_scc1 L_VOK1
  s_cbranch_vccz L_VOK1
  s_add_u32 m0, s66, 32768
  s_nop 0
  buffer_load_dwordx4 v23, s[28:31], s68 offen offset:0 sc1 lds
  buffer_load_dwordx4 v23, s[28:31], s68 offen offset:1024 sc1 lds
  buffer_load_dwordx4 v23, s[28:31], s68 offen offset:2048 sc1 lds
  buffer_load_dwordx4 v23, s[28:31], s68 offen offset:3072 sc1 lds
  buffer_load_dword v45, v43, s[28:31], s4 offen sc1
  s_waitcnt vmcnt(0)
  s_branch L_VER1
L_VOK1:
  v_mov_b32 v104, 34
  s_mov_b64 exec, 1
  ds_max_u32 v25, v104
  s_mov_b64 exec, -1
  s_waitcnt vmcnt(5)
L_VER2:
  v_add_u32 v42, s66, v23
  v_add_u32 v42, 0x14000, v42
  ds_read_b128 v[48:51], v42 offset:0
  ds_read_b128 v[52:55], v42 offset:1024
  ds_read_b128 v[56:59], v42 offset:2048
  ds_read_b128 v[60:63], v42 offset:3072
  s_waitcnt lgkmcnt(0)
  v_xor_b32 v42, s58, v46
  v_xor_b32 v42, v48, v42
  v_xor_b32 v42, v49, v42
  v_xor_b32 v42, v50, v42
  v_xor_b32 v42, v51, v42
  v_xor_b32 v42, v52, v42
  v_xor_b32 v42, v53, v42
  v_xor_b32 v42, v54, v42
  v_xor_b32 v42, v55, v42
  v_xor_b32 v42, v56, v42
  v_xor_b32 v42, v57, v42
  v_xor_b32 v42, v58, v42
  v_xor_b32 v42, v59, v42
  v_xor_b32 v42, v60, v42
  v_xor_b32 v42, v61, v42
  v_xor_b32 v42, v62, v42
  v_xor_b32 v42, v63, v42
  v_cmp_ne_u32 vcc, 0, v42
  s_add_u32 s63, s63, 1
  s_cmp_gt_u32 s63, 40000
  s_cbranch_scc1 L_VOK2
  s_cbranch_vccz L_VOK2
  s_add_u32 m0, s66, 81920
  s_nop 0
  buffer_load_dwordx4 v23, s[28:31], s70 offen offset:0 sc1 lds
  buffer_load_dwordx4 v23, s[28:31], s70 offen offset:1024 sc1 lds
  buffer_load_dwordx4 v23, s[28:31], s70 offen offset:2048 sc1 lds
  buffer_load_dwordx4 v23, s[28:31], s70 offen offset:3072 sc1 lds
  buffer_load_dword v46, v43, s[28:31], s5 offen sc1
  s_waitcnt vmcnt(0)
  s_branch L_VER2
L_VOK2:
  v_mov_b32 v104, 35
  s_mov_b64 exec, 1
  ds_max_u32 v25, v104
  s_mov_b64 exec, -1
  s_waitcnt vmcnt(0)
L_VER3:
  v_add_u32 v42, s66, v23
  v_add_u32 v42, 0x18000, v42
  ds_read_b128 v[48:51], v42 offset:0
  ds_read_b128 v[52:55], v42 offset:1024
  ds_read_b128 v[56:59], v42 offset:2048
  ds_read_b128 v[60:63], v42 offset:3072
  s_waitcnt lgkmcnt(0)
  v_xor_b32 v42, s58, v47
  v_xor_b32 v42, v48, v42
  v_xor_b32 v42, v49, v42
  v_xor_b32 v42, v50, v42
  v_xor_b32 v42, v51, v42
  v_xor_b32 v42, v52, v42
  v_xor_b32 v42, v53, v42
  v_xor_b32 v42, v54, v42
  v_xor_b32 v42, v55, v42
  v_xor_b32 v42, v56, v42
  v_xor_b32 v42, v57, v42
  v_xor_b32 v42, v58, v42
  v_xor_b32 v42, v59, v42
  v_xor_b32 v42, v60, v42
  v_xor_b32 v42, v61, v42
  v_xor_b32 v42, v62, v42
  v_xor_b32 v42, v63, v42
  v_cmp_ne_u32 vcc, 0, v42
  s_add_u32 s63, s63, 1
  s_cmp_gt_u32 s63, 40000
  s_cbranch_scc1 L_VOK3
  s_cbranch_vccz L_VOK3
  s_add_u32 m0, s66, 98304
  s_nop 0
  buffer_load_dwordx4 v23, s[28:31], s71 offen offset:0 sc1 lds
  buffer_load_dwordx4 v23, s[28:31], s71 offen offset:1024 sc1 lds
  buffer_load_dwordx4 v23, s[28:31], s71 offen offset:2048 sc1 lds
  buffer_load_dwordx4 v23, s[28:31], s71 offen offset:3072 sc1 lds
  buffer_load_dword v47, v43, s[28:31], s6 offen sc1
  s_waitcnt vmcnt(0)
  s_branch L_VER3
L_VOK3:
  v_mov_b32 v104, 36
  s_mov_b64 exec, 1
  ds_max_u32 v25, v104
  s_mov_b64 exec, -1
  ds_read_b128 v[108:111], v24 offset:16
  s_lshl_b32 s60, s53, 1
  s_add_u32 s60, s60, 6
  s_and_b32 s60, s60, 7
  s_mul_i32 s60, s60, 73728
  s_add_u32 s60, s60, s67
  s_lshl_b32 s61, s53, 8
  s_add_u32 m0, s66, 114688
  s_add_u32 s60, s60, s61
  buffer_load_dwordx4 v15, s[24:27], s60 offen offset:0 lds
  buffer_load_dwordx4 v16, s[24:27], s60 offen offset:1024 lds
  buffer_load_dwordx4 v17, s[24:27], s60 offen offset:2048 lds
  buffer_load_dwordx4 v18, s[24:27], s60 offen offset:3072 lds
  s_waitcnt lgkmcnt(0)
  v_min3_u32 v108, v108, v109, v110
  v_min_u32 v108, v108, v111
  s_nop 0
  v_readfirstlane_b32 s92, v108
  s_cmp_ge_u32 s92, 30
  s_cbranch_scc1 L_OK129
L_SP130:
  ds_read_b128 v[104:107], v24 offset:16
  s_waitcnt lgkmcnt(0)
  v_min3_u32 v104, v104, v105, v106
  v_min_u32 v104, v104, v107
  s_nop 0
  v_readfirstlane_b32 s92, v104
  s_add_i32 s93, s93, -1
  s_cmp_lt_i32 s93, 0
  s_cbranch_scc1 L_OK129
  s_cmp_ge_u32 s92, 30
  s_cbranch_scc1 L_OK129
  s_sleep 3
  s_branch L_SP130
L_OK129:
  ds_read_b128 v[108:111], v24 offset:16
  s_lshl_b32 s60, s53, 1
  s_add_u32 s60, s60, 7
  s_and_b32 s60, s60, 7
  s_mul_i32 s60, s60, 73728
  s_add_u32 s60, s60, s67
  s_lshl_b32 s61, s53, 8
  s_add_u32 m0, s66, 65536
  s_add_u32 s60, s60, s61
  buffer_load_dwordx4 v15, s[24:27], s60 offen offset:0 lds
  buffer_load_dwordx4 v16, s[24:27], s60 offen offset:1024 lds
  buffer_load_dwordx4 v17, s[24:27], s60 offen offset:2048 lds
  buffer_load_dwordx4 v18, s[24:27], s60 offen offset:3072 lds
  s_waitcnt vmcnt(4)
  v_mov_b32 v104, 37
  s_mov_b64 exec, 1
  ds_max_u32 v25, v104
  s_mov_b64 exec, -1
  s_waitcnt lgkmcnt(1)
  v_min3_u32 v108, v108, v109, v110
  v_min_u32 v108, v108, v111
  s_nop 0
  v_readfirstlane_b32 s92, v108
  s_waitcnt vmcnt(0)
  v_mov_b32 v104, 38
  s_mov_b64 exec, 1
  ds_max_u32 v25, v104
  s_mov_b64 exec, -1
  s_branch L_FINAL
L_COMPUTE:
  s_cmp_eq_u32 s56, 3
  s_cbranch_scc0 L_NOCPF
  s_getpc_b64 s[4:5]
L_PCREF:
  s_lshr_b32 s60, s59, 3
  s_mul_i32 s60, s60, 512
  s_add_u32 s4, s4, s60
  s_addc_u32 s5, s5, 0
  v_lshlrev_b32 v9, 7, v1
  s_mov_b64 exec, 0xf
  global_load_dword v9, v9, s[4:5]
  s_mov_b64 exec, -1
L_NOCPF:
  s_setprio 1
  s_and_b32 s57, s56, 1
  s_lshl_b32 s66, s57, 13
  s_lshr_b32 s67, s56, 1
  s_mov_b32 s64, 0x3e0293ee
  s_mov_b32 s65, 0x3e0293ee
  v_mov_b32 v43, v2
  v_mov_b32 v44, v3
  v_lshrrev_b32 v32, 5, v1
  v_lshrrev_b32 v33, 2, v3
  v_and_b32 v34, 3, v1
  v_and_b32 v35, 1, v2
  v_and_b32 v36, 31, v1
  s_waitcnt lgkmcnt(0)
  s_mov_b32 s28, s50
  s_mov_b32 s29, s51
  s_mov_b32 s30, 0x10000000
  s_mov_b32 s31, 0x00020000
  s_mov_b32 s32, s46
  s_mov_b32 s33, s47
  s_mov_b32 s34, 0x90000
  s_mov_b32 s35, 0x00020000
  s_mul_i32 s68, s59, 16384
  s_add_u32 s68, s68, 0x100000
  s_mul_i32 s69, s59, 24576
  s_mul_i32 s60, s56, 6144
  s_add_u32 s69, s69, s60
  s_add_u32 s69, s69, 0x800000
  s_lshl_b32 s60, s54, 7
  v_mov_b32 v31, s60
  buffer_load_dword v16, v31, s[28:31], 0 offen sc1
  v_lshlrev_b32 v37, 7, v36
  v_add_u32 v37, 0x20000, v37
  v_bfe_u32 v38, v36, 1, 3
  v_xor_b32 v38, v32, v38
  v_lshlrev_b32 v38, 4, v38
  v_add_u32 v4, v37, v38
  v_xor_b32 v5, 32, v4
  v_xor_b32 v6, 64, v4
  v_xor_b32 v7, 96, v4
  v_and_b32 v37, 1, v34
  v_lshlrev_b32 v37, 1, v37
  v_lshrrev_b32 v38, 1, v34
  v_or_b32 v40, v37, v38
  v_lshl_add_u32 v41, v32, 3, v33
  v_xor_b32 v37, s56, v33
  v_lshlrev_b32 v37, 6, v37
  v_lshrrev_b32 v38, 1, v40
  v_lshl_add_u32 v38, v35, 1, v38
  v_lshl_add_u32 v37, v38, 4, v37
  v_and_b32 v38, 1, v40
  v_lshl_add_u32 v37, v38, 3, v37
  v_lshl_add_u32 v8, v41, 8, v37
  v_xor_b32 v37, v32, v44
  v_lshlrev_b32 v37, 4, v37
  v_lshl_add_u32 v10, v36, 8, v37
  v_add_u32 v10, s66, v10
  v_lshl_add_u32 v42, v32, 2, v33
  s_lshl_b32 s60, s57, 1
  s_xor_b32 s60, s60, 0
  v_xor_b32 v37, s60, v33
  v_lshlrev_b32 v37, 6, v37
  v_lshrrev_b32 v38, 1, v34
  v_lshl_add_u32 v38, v35, 1, v38
  v_lshl_add_u32 v37, v38, 4, v37
  v_and_b32 v38, 1, v34
  v_lshl_add_u32 v37, v38, 3, v37
  v_lshl_add_u32 v11, v42, 8, v37
  v_add_u32 v11, s66, v11
  s_lshl_b32 s60, s57, 1
  s_xor_b32 s60, s60, 1
  v_xor_b32 v37, s60, v33
  v_lshlrev_b32 v37, 6, v37
  v_lshrrev_b32 v38, 1, v34
  v_lshl_add_u32 v38, v35, 1, v38
  v_lshl_add_u32 v37, v38, 4, v37
  v_and_b32 v38, 1, v34
  v_lshl_add_u32 v37, v38, 3, v37
  v_lshl_add_u32 v12, v42, 8, v37
  v_add_u32 v12, s66, v12
  s_lshl_b32 s60, s57, 1
  s_xor_b32 s60, s60, 2
  v_xor_b32 v37, s60, v33
  v_lshlrev_b32 v37, 6, v37
  v_lshrrev_b32 v38, 1, v34
  v_lshl_add_u32 v38, v35, 1, v38
  v_lshl_add_u32 v37, v38, 4, v37
  v_and_b32 v38, 1, v34
  v_lshl_add_u32 v37, v38, 3, v37
  v_lshl_add_u32 v13, v42, 8, v37
  v_add_u32 v13, s66, v13
  s_lshl_b32 s60, s57, 1
  s_xor_b32 s60, s60, 3
  v_xor_b32 v37, s60, v33
  v_lshlrev_b32 v37, 6, v37
  v_lshrrev_b32 v38, 1, v34
  v_lshl_add_u32 v38, v35, 1, v38
  v_lshl_add_u32 v37, v38, 4, v37
  v_and_b32 v38, 1, v34
  v_lshl_add_u32 v37, v38, 3, v37
  v_lshl_add_u32 v14, v42, 8, v37
  v_add_u32 v14, s66, v14
  v_xor_b32 v37, s56, v33
  v_lshlrev_b32 v37, 6, v37
  v_lshrrev_b32 v38, 1, v34
  v_lshl_add_u32 v38, v35, 1, v38
  v_lshl_add_u32 v37, v38, 4, v37
  v_and_b32 v38, 1, v34
  v_lshl_add_u32 v37, v38, 3, v37
  v_lshl_add_u32 v15, v42, 8, v37
  v_lshlrev_b32 v27, 4, v1
  s_lshl_b32 s60, s67, 13
  v_add_u32 v17, s60, v27
  v_lshrrev_b32 v37, 1, v43
  v_lshlrev_b32 v37, 4, v37
  v_lshl_add_u32 v37, v35, 2, v37
  v_add_u32 v37, v37, v33
  v_lshlrev_b32 v37, 5, v37
  v_lshl_add_u32 v37, v34, 3, v37
  v_add_u32 v18, 0x20000, v37
  v_lshrrev_b32 v37, 1, v43
  v_lshlrev_b32 v37, 10, v37
  v_lshl_add_u32 v38, v35, 5, v44
  v_lshl_add_u32 v37, v38, 4, v37
  s_lshl_b32 s60, s67, 13
  s_lshl_b32 s61, s57, 8
  s_add_u32 s60, s60, s61
  v_add_u32 v19, s60, v37
  s_lshl_b32 s60, s57, 12
  v_add_u32 v26, s60, v17
  v_mov_b32 v2, 0x26000
  s_lshl_b32 s60, s56, 2
  s_add_u32 s60, s60, 0x26000
  v_mov_b32 v3, s60
  s_xor_b32 s60, s60, 4
  v_mov_b32 v0, s60
  v_add_u32 v20, 0xc000, v8
  v_subrev_u32 v22, 0x8000, v4
  v_subrev_u32 v23, 0x8000, v5
  v_subrev_u32 v24, 0x8000, v6
  v_subrev_u32 v25, 0x8000, v7
  s_barrier
  s_cmp_ge_u32 s92, 1
  s_cbranch_scc1 L_OK1
L_SP2:
  ds_read_b128 v[28:31], v2 offset:0
  s_waitcnt lgkmcnt(0)
  v_min3_u32 v28, v28, v29, v30
  v_min_u32 v28, v28, v31
  s_nop 0
  v_readfirstlane_b32 s92, v28
  s_add_i32 s93, s93, -1
  s_cmp_lt_i32 s93, 0
  s_cbranch_scc1 L_OK1
  s_cmp_ge_u32 s92, 1
  s_cbranch_scc0 L_SP2
L_OK1:
  ds_read_b64_tr_b16 v[32:33], v8 offset:0
  ds_read_b64_tr_b16 v[34:35], v8 offset:1024
  ds_read_b128 v[96:99], v4 offset:0
  ds_read_b128 v[100:103], v4 offset:4096
  ds_read_b64_tr_b16 v[36:37], v8 offset:4096
  ds_read_b64_tr_b16 v[38:39], v8 offset:5120
  ds_read_b128 v[104:107], v5 offset:0
  ds_read_b128 v[108:111], v5 offset:4096
  ds_read_b64_tr_b16 v[40:41], v8 offset:8192
  ds_read_b64_tr_b16 v[42:43], v8 offset:9216
  ds_read_b128 v[112:115], v6 offset:0
  ds_read_b128 v[116:119], v6 offset:4096
  s_waitcnt lgkmcnt(9)
  v_mfma_f32_32x32x16_bf16 v[128:143], v[32:35], v[96:99], 0
  ds_read_b64_tr_b16 v[44:45], v8 offset:12288
  ds_read_b64_tr_b16 v[46:47], v8 offset:13312
  ds_read_b128 v[120:123], v7 offset:0
  s_waitcnt lgkmcnt(11)
  v_mfma_f32_32x32x16_bf16 v[144:159], v[32:35], v[100:103], 0
  ds_read_b128 v[124:127], v7 offset:4096
  v_mov_b32 v28, 1
  s_mov_b64 exec, 1
  ds_write_b32 v3, v28 offset:16
  s_mov_b64 exec, -1
  s_waitcnt lgkmcnt(10)
  v_mfma_f32_32x32x16_bf16 v[128:143], v[36:39], v[104:107], v[128:143]
  s_cmp_ge_u32 s92, 2
  s_cbranch_scc1 L_OK3
L_SP4:
  ds_read_b128 v[28:31], v2 offset:0
  s_waitcnt lgkmcnt(0)
  v_min3_u32 v28, v28, v29, v30
  v_min_u32 v28, v28, v31
  s_nop 0
  v_readfirstlane_b32 s92, v28
  s_add_i32 s93, s93, -1
  s_cmp_lt_i32 s93, 0
  s_cbranch_scc1 L_OK3
  s_cmp_ge_u32 s92, 2
  s_cbranch_scc0 L_SP4
L_OK3:
  ds_read_b64_tr_b16 v[32:33], v8 offset:16384
  ds_read_b64_tr_b16 v[34:35], v8 offset:17408
  ds_read_b128 v[96:99], v4 offset:8192
  s_waitcnt lgkmcnt(12)
  v_mfma_f32_32x32x16_bf16 v[144:159], v[36:39], v[108:111], v[144:159]
  ds_read_b128 v[100:103], v4 offset:12288
  s_waitcnt lgkmcnt(10)
  v_mfma_f32_32x32x16_bf16 v[128:143], v[40:43], v[112:115], v[128:143]
  ds_read_b64_tr_b16 v[36:37], v8 offset:20480
  ds_read_b64_tr_b16 v[38:39], v8 offset:21504
  ds_read_b128 v[104:107], v5 offset:8192
  s_waitcnt lgkmcnt(12)
  v_mfma_f32_32x32x16_bf16 v[144:159], v[40:43], v[116:119], v[144:159]
  ds_read_b128 v[108:111], v5 offset:12288
  s_waitcnt lgkmcnt(10)
  v_mfma_f32_32x32x16_bf16 v[128:143], v[44:47], v[120:123], v[128:143]
  ds_read_b64_tr_b16 v[40:41], v8 offset:24576
  ds_read_b64_tr_b16 v[42:43], v8 offset:25600
  ds_read_b128 v[112:115], v6 offset:8192
  s_waitcnt lgkmcnt(12)
  v_mfma_f32_32x32x16_bf16 v[144:159], v[44:47], v[124:127], v[144:159]
  ds_read_b128 v[116:119], v6 offset:12288
  s_waitcnt lgkmcnt(9)
  v_mfma_f32_32x32x16_bf16 v[128:143], v[32:35], v[96:99], v[128:143]
  ds_read_b64_tr_b16 v[44:45], v8 offset:28672
  ds_read_b64_tr_b16 v[46:47], v8 offset:29696
  ds_read_b128 v[120:123], v7 offset:8192
  s_waitcnt lgkmcnt(11)
  v_mfma_f32_32x32x16_bf16 v[144:159], v[32:35], v[100:103], v[144:159]
  ds_read_b128 v[124:127], v7 offset:12288
  v_mov_b32 v28, 2
  s_mov_b64 exec, 1
  ds_write_b32 v3, v28 offset:16
  s_mov_b64 exec, -1
  s_waitcnt lgkmcnt(10)
  v_mfma_f32_32x32x16_bf16 v[128:143], v[36:39], v[104:107], v[128:143]
  s_cmp_ge_u32 s92, 3
  s_cbranch_scc1 L_OK5
L_SP6:
  ds_read_b128 v[28:31], v2 offset:0
  s_waitcnt lgkmcnt(0)
  v_min3_u32 v28, v28, v29, v30
  v_min_u32 v28, v28, v31
  s_nop 0
  v_readfirstlane_b32 s92, v28
  s_add_i32 s93, s93, -1
  s_cmp_lt_i32 s93, 0
  s_cbranch_scc1 L_OK5
  s_cmp_ge_u32 s92, 3
  s_cbranch_scc0 L_SP6
L_OK5:
  ds_read_b64_tr_b16 v[32:33], v8 offset:32768
  ds_read_b64_tr_b16 v[34:35], v8 offset:33792
  ds_read_b128 v[96:99], v4 offset:16384
  s_waitcnt lgkmcnt(12)
  v_mfma_f32_32x32x16_bf16 v[144:159], v[36:39], v[108:111], v[144:159]
  ds_read_b128 v[100:103], v4 offset:20480
  s_waitcnt lgkmcnt(10)
  v_mfma_f32_32x32x16_bf16 v[128:143], v[40:43], v[112:115], v[128:143]
  ds_read_b64_tr_b16 v[36:37], v8 offset:36864
  ds_read_b64_tr_b16 v[38:39], v8 offset:37888
  ds_read_b128 v[104:107], v5 offset:16384
  s_waitcnt lgkmcnt(12)
  v_mfma_f32_32x32x16_bf16 v[144:159], v[40:43], v[116:119], v[144:159]
  ds_read_b128 v[108:111], v5 offset:20480
  s_waitcnt lgkmcnt(10)
  v_mfma_f32_32x32x16_bf16 v[128:143], v[44:47], v[120:123], v[128:143]
  ds_read_b64_tr_b16 v[40:41], v8 offset:40960
  ds_read_b64_tr_b16 v[42:43], v8 offset:41984
  ds_read_b128 v[112:115], v6 offset:16384
  s_waitcnt lgkmcnt(12)
  v_mfma_f32_32x32x16_bf16 v[144:159], v[44:47], v[124:127], v[144:159]
  ds_read_b128 v[116:119], v6 offset:20480
  s_waitcnt lgkmcnt(9)
  v_mfma_f32_32x32x16_bf16 v[128:143], v[32:35], v[96:99], v[128:143]
  ds_read_b64_tr_b16 v[44:45], v8 offset:45056
  ds_read_b64_tr_b16 v[46:47], v8 offset:46080
  ds_read_b128 v[120:123], v7 offset:16384
  s_waitcnt lgkmcnt(11)
  v_mfma_f32_32x32x16_bf16 v[144:159], v[32:35], v[100:103], v[144:159]
  ds_read_b128 v[124:127], v7 offset:20480
  v_mov_b32 v28, 3
  s_mov_b64 exec, 1
  ds_write_b32 v3, v28 offset:16
  s_mov_b64 exec, -1
  s_waitcnt lgkmcnt(10)
  v_mfma_f32_32x32x16_bf16 v[128:143], v[36:39], v[104:107], v[128:143]
  s_cmp_ge_u32 s92, 4
  s_cbranch_scc1 L_OK7
L_SP8:
  ds_read_b128 v[28:31], v2 offset:0
  s_waitcnt lgkmcnt(0)
  v_min3_u32 v28, v28, v29, v30
  v_min_u32 v28, v28, v31
  s_nop 0
  v_readfirstlane_b32 s92, v28
  s_add_i32 s93, s93, -1
  s_cmp_lt_i32 s93, 0
  s_cbranch_scc1 L_OK7
  s_cmp_ge_u32 s92, 4
  s_cbranch_scc0 L_SP8
L_OK7:
  ds_read_b64_tr_b16 v[32:33], v20 offset:0
  ds_read_b64_tr_b16 v[34:35], v20 offset:1024
  ds_read_b128 v[96:99], v22 offset:16384
  s_waitcnt lgkmcnt(12)
  v_mfma_f32_32x32x16_bf16 v[144:159], v[36:39], v[108:111], v[144:159]
  ds_read_b128 v[100:103], v22 offset:20480
  s_waitcnt lgkmcnt(10)
  v_mfma_f32_32x32x16_bf16 v[128:143], v[40:43], v[112:115], v[128:143]
  ds_read_b64_tr_b16 v[36:37], v20 offset:4096
  ds_read_b64_tr_b16 v[38:39], v20 offset:5120
  ds_read_b128 v[104:107], v23 offset:16384
  s_waitcnt lgkmcnt(12)
  v_mfma_f32_32x32x16_bf16 v[144:159], v[40:43], v[116:119], v[144:159]
  ds_read_b128 v[108:111], v23 offset:20480
  s_waitcnt lgkmcnt(10)
  v_mfma_f32_32x32x16_bf16 v[128:143], v[44:47], v[120:123], v[128:143]
  ds_read_b64_tr_b16 v[40:41], v20 offset:8192
  ds_read_b64_tr_b16 v[42:43], v20 offset:9216
  ds_read_b128 v[112:115], v24 offset:16384
  s_waitcnt lgkmcnt(12)
  v_mfma_f32_32x32x16_bf16 v[144:159], v[44:47], v[124:127], v[144:159]
  ds_read_b128 v[116:119], v24 offset:20480
  s_waitcnt lgkmcnt(9)
  v_mfma_f32_32x32x16_bf16 v[128:143], v[32:35], v[96:99], v[128:143]
  ds_read_b64_tr_b16 v[44:45], v20 offset:12288
  ds_read_b64_tr_b16 v[46:47], v20 offset:13312
  ds_read_b128 v[120:123], v25 offset:16384
  s_waitcnt lgkmcnt(11)
  v_mfma_f32_32x32x16_bf16 v[144:159], v[32:35], v[100:103], v[144:159]
  ds_read_b128 v[124:127], v25 offset:20480
  v_mov_b32 v28, 4
  s_mov_b64 exec, 1
  ds_write_b32 v3, v28 offset:16
  s_mov_b64 exec, -1
  s_waitcnt lgkmcnt(10)
  v_mfma_f32_32x32x16_bf16 v[128:143], v[36:39], v[104:107], v[128:143]
  s_cmp_ge_u32 s92, 5
  s_cbranch_scc1 L_OK9
L_SP10:
  ds_read_b128 v[28:31], v2 offset:0
  s_waitcnt lgkmcnt(0)
  v_min3_u32 v28, v28, v29, v30
  v_min_u32 v28, v28, v31
  s_nop 0
  v_readfirstlane_b32 s92, v28
  s_add_i32 s93, s93, -1
  s_cmp_lt_i32 s93, 0
  s_cbranch_scc1 L_OK9
  s_cmp_ge_u32 s92, 5
  s_cbranch_scc0 L_SP10
L_OK9:
  ds_read_b64_tr_b16 v[32:33], v20 offset:16384
  ds_read_b64_tr_b16 v[34:35], v20 offset:17408
  ds_read_b128 v[96:99], v22 offset:24576
  s_waitcnt lgkmcnt(12)
  v_mfma_f32_32x32x16_bf16 v[144:159], v[36:39], v[108:111], v[144:159]
  ds_read_b128 v[100:103], v22 offset:28672
  s_waitcnt lgkmcnt(10)
  v_mfma_f32_32x32x16_bf16 v[128:143], v[40:43], v[112:115], v[128:143]
  ds_read_b64_tr_b16 v[36:37], v20 offset:20480
  ds_read_b64_tr_b16 v[38:39], v20 offset:21504
  ds_read_b128 v[104:107], v23 offset:24576
  s_waitcnt lgkmcnt(12)
  v_mfma_f32_32x32x16_bf16 v[144:159], v[40:43], v[116:119], v[144:159]
  ds_read_b128 v[108:111], v23 offset:28672
  s_waitcnt lgkmcnt(10)
  v_mfma_f32_32x32x16_bf16 v[128:143], v[44:47], v[120:123], v[128:143]
  ds_read_b64_tr_b16 v[40:41], v20 offset:24576
  ds_read_b64_tr_b16 v[42:43], v20 offset:25600
  ds_read_b128 v[112:115], v24 offset:24576
  s_waitcnt lgkmcnt(12)
  v_mfma_f32_32x32x16_bf16 v[144:159], v[44:47], v[124:127], v[144:159]
  ds_read_b128 v[116:119], v24 offset:28672
  s_waitcnt lgkmcnt(9)
  v_mfma_f32_32x32x16_bf16 v[128:143], v[32:35], v[96:99], v[128:143]
  ds_read_b64_tr_b16 v[44:45], v20 offset:28672
  ds_read_b64_tr_b16 v[46:47], v20 offset:29696
  ds_read_b128 v[120:123], v25 offset:24576
  s_waitcnt lgkmcnt(11)
  v_mfma_f32_32x32x16_bf16 v[144:159], v[32:35], v[100:103], v[144:159]
  ds_read_b128 v[124:127], v25 offset:28672
  v_mov_b32 v28, 5
  s_mov_b64 exec, 1
  ds_write_b32 v3, v28 offset:16
  s_mov_b64 exec, -1
  s_waitcnt lgkmcnt(10)
  v_mfma_f32_32x32x16_bf16 v[128:143], v[36:39], v[104:107], v[128:143]
  s_cmp_ge_u32 s92, 6
  s_cbranch_scc1 L_OK11
L_SP12:
  ds_read_b128 v[28:31], v2 offset:0
  s_waitcnt lgkmcnt(0)
  v_min3_u32 v28, v28, v29, v30
  v_min_u32 v28, v28, v31
  s_nop 0
  v_readfirstlane_b32 s92, v28
  s_add_i32 s93, s93, -1
  s_cmp_lt_i32 s93, 0
  s_cbranch_scc1 L_OK11
  s_cmp_ge_u32 s92, 6
  s_cbranch_scc0 L_SP12
L_OK11:
  ds_read_b64_tr_b16 v[32:33], v20 offset:32768
  ds_read_b64_tr_b16 v[34:35], v20 offset:33792
  ds_read_b128 v[96:99], v22 offset:0
  s_waitcnt lgkmcnt(12)
  v_mfma_f32_32x32x16_bf16 v[144:159], v[36:39], v[108:111], v[144:159]
  ds_read_b128 v[100:103], v22 offset:4096
  s_waitcnt lgkmcnt(10)
  v_mfma_f32_32x32x16_bf16 v[128:143], v[40:43], v[112:115], v[128:143]
  ds_read_b64_tr_b16 v[36:37], v20 offset:36864
  ds_read_b64_tr_b16 v[38:39], v20 offset:37888
  ds_read_b128 v[104:107], v23 offset:0
  s_waitcnt lgkmcnt(12)
  v_mfma_f32_32x32x16_bf16 v[144:159], v[40:43], v[116:119], v[144:159]
  ds_read_b128 v[108:111], v23 offset:4096
  s_waitcnt lgkmcnt(10)
  v_mfma_f32_32x32x16_bf16 v[128:143], v[44:47], v[120:123], v[128:143]
  ds_read_b64_tr_b16 v[40:41], v20 offset:40960
  ds_read_b64_tr_b16 v[42:43], v20 offset:41984
  ds_read_b128 v[112:115], v24 offset:0
  s_waitcnt lgkmcnt(12)
  v_mfma_f32_32x32x16_bf16 v[144:159], v[44:47], v[124:127], v[144:159]
  ds_read_b128 v[116:119], v24 offset:4096
  s_waitcnt lgkmcnt(9)
  v_mfma_f32_32x32x16_bf16 v[128:143], v[32:35], v[96:99], v[128:143]
  ds_read_b64_tr_b16 v[44:45], v20 offset:45056
  ds_read_b64_tr_b16 v[46:47], v20 offset:46080
  ds_read_b128 v[120:123], v25 offset:0
  s_waitcnt lgkmcnt(11)
  v_mfma_f32_32x32x16_bf16 v[144:159], v[32:35], v[100:103], v[144:159]
  ds_read_b128 v[124:127], v25 offset:4096
  v_mov_b32 v28, 6
  s_mov_b64 exec, 1
  ds_write_b32 v3, v28 offset:16
  s_mov_b64 exec, -1
  s_waitcnt lgkmcnt(10)
  v_mfma_f32_32x32x16_bf16 v[128:143], v[36:39], v[104:107], v[128:143]
  s_cmp_ge_u32 s92, 7
  s_cbranch_scc1 L_OK13
L_SP14:
  ds_read_b128 v[28:31], v2 offset:0
  s_waitcnt lgkmcnt(0)
  v_min3_u32 v28, v28, v29, v30
  v_min_u32 v28, v28, v31
  s_nop 0
  v_readfirstlane_b32 s92, v28
  s_add_i32 s93, s93, -1
  s_cmp_lt_i32 s93, 0
  s_cbranch_scc1 L_OK13
  s_cmp_ge_u32 s92, 7
  s_cbranch_scc0 L_SP14
L_OK13:
  ds_read_b64_tr_b16 v[32:33], v8 offset:0
  ds_read_b64_tr_b16 v[34:35], v8 offset:1024
  ds_read_b128 v[96:99], v4 offset:0
  s_waitcnt lgkmcnt(12)
  v_mfma_f32_32x32x16_bf16 v[144:159], v[36:39], v[108:111], v[144:159]
  ds_read_b128 v[100:103], v4 offset:4096
  s_waitcnt lgkmcnt(10)
  v_mfma_f32_32x32x16_bf16 v[128:143], v[40:43], v[112:115], v[128:143]
  ds_read_b64_tr_b16 v[36:37], v8 offset:4096
  ds_read_b64_tr_b16 v[38:39], v8 offset:5120
  ds_read_b128 v[104:107], v5 offset:0
  s_waitcnt lgkmcnt(12)
  v_mfma_f32_32x32x16_bf16 v[144:159], v[40:43], v[116:119], v[144:159]
  ds_read_b128 v[108:111], v5 offset:4096
  s_waitcnt lgkmcnt(10)
  v_mfma_f32_32x32x16_bf16 v[128:143], v[44:47], v[120:123], v[128:143]
  ds_read_b64_tr_b16 v[40:41], v8 offset:8192
  ds_read_b64_tr_b16 v[42:43], v8 offset:9216
  ds_read_b128 v[112:115], v6 offset:0
  s_waitcnt lgkmcnt(12)
  v_mfma_f32_32x32x16_bf16 v[144:159], v[44:47], v[124:127], v[144:159]
  ds_read_b128 v[116:119], v6 offset:4096
  s_waitcnt lgkmcnt(9)
  v_mfma_f32_32x32x16_bf16 v[128:143], v[32:35], v[96:99], v[128:143]
  ds_read_b64_tr_b16 v[44:45], v8 offset:12288
  ds_read_b64_tr_b16 v[46:47], v8 offset:13312
  ds_read_b128 v[120:123], v7 offset:0
  s_waitcnt lgkmcnt(11)
  v_mfma_f32_32x32x16_bf16 v[144:159], v[32:35], v[100:103], v[144:159]
  ds_read_b128 v[124:127], v7 offset:4096
  v_mov_b32 v28, 7
  s_mov_b64 exec, 1
  ds_write_b32 v3, v28 offset:16
  s_mov_b64 exec, -1
  s_waitcnt lgkmcnt(10)
  v_mfma_f32_32x32x16_bf16 v[128:143], v[36:39], v[104:107], v[128:143]
  s_cmp_ge_u32 s92, 8
  s_cbranch_scc1 L_OK15
L_SP16:
  ds_read_b128 v[28:31], v2 offset:0
  s_waitcnt lgkmcnt(0)
  v_min3_u32 v28, v28, v29, v30
  v_min_u32 v28, v28, v31
  s_nop 0
  v_readfirstlane_b32 s92, v28
  s_add_i32 s93, s93, -1
  s_cmp_lt_i32 s93, 0
  s_cbranch_scc1 L_OK15
  s_cmp_ge_u32 s92, 8
  s_cbranch_scc0 L_SP16
L_OK15:
  ds_read_b64_tr_b16 v[32:33], v8 offset:16384
  ds_read_b64_tr_b16 v[34:35], v8 offset:17408
  ds_read_b128 v[96:99], v4 offset:8192
  s_waitcnt lgkmcnt(12)
  v_mfma_f32_32x32x16_bf16 v[144:159], v[36:39], v[108:111], v[144:159]
  ds_read_b128 v[100:103], v4 offset:12288
  s_waitcnt lgkmcnt(10)
  v_mfma_f32_32x32x16_bf16 v[128:143], v[40:43], v[112:115], v[128:143]
  ds_read_b64_tr_b16 v[36:37], v8 offset:20480
  ds_read_b64_tr_b16 v[38:39], v8 offset:21504
  ds_read_b128 v[104:107], v5 offset:8192
  s_waitcnt lgkmcnt(12)
  v_mfma_f32_32x32x16_bf16 v[144:159], v[40:43], v[116:119], v[144:159]
  ds_read_b128 v[108:111], v5 offset:12288
  s_waitcnt lgkmcnt(10)
  v_mfma_f32_32x32x16_bf16 v[128:143], v[44:47], v[120:123], v[128:143]
  ds_read_b64_tr_b16 v[40:41], v8 offset:24576
  ds_read_b64_tr_b16 v[42:43], v8 offset:25600
  ds_read_b128 v[112:115], v6 offset:8192
  s_waitcnt lgkmcnt(12)
  v_mfma_f32_32x32x16_bf16 v[144:159], v[44:47], v[124:127], v[144:159]
  ds_read_b128 v[116:119], v6 offset:12288
  s_waitcnt lgkmcnt(9)
  v_mfma_f32_32x32x16_bf16 v[128:143], v[32:35], v[96:99], v[128:143]
  ds_read_b64_tr_b16 v[44:45], v8 offset:28672
  ds_read_b64_tr_b16 v[46:47], v8 offset:29696
  ds_read_b128 v[120:123], v7 offset:8192
  s_waitcnt lgkmcnt(11)
  v_mfma_f32_32x32x16_bf16 v[144:159], v[32:35], v[100:103], v[144:159]
  ds_read_b128 v[124:127], v7 offset:12288
  v_mov_b32 v28, 8
  s_mov_b64 exec, 1
  ds_write_b32 v3, v28 offset:16
  s_mov_b64 exec, -1
  s_waitcnt lgkmcnt(10)
  v_mfma_f32_32x32x16_bf16 v[128:143], v[36:39], v[104:107], v[128:143]
  s_cmp_ge_u32 s92, 9
  s_cbranch_scc1 L_OK17
L_SP18:
  ds_read_b128 v[28:31], v2 offset:0
  s_waitcnt lgkmcnt(0)
  v_min3_u32 v28, v28, v29, v30
  v_min_u32 v28, v28, v31
  s_nop 0
  v_readfirstlane_b32 s92, v28
  s_add_i32 s93, s93, -1
  s_cmp_lt_i32 s93, 0
  s_cbranch_scc1 L_OK17
  s_cmp_ge_u32 s92, 9
  s_cbranch_scc0 L_SP18
L_OK17:
  ds_read_b64_tr_b16 v[32:33], v8 offset:32768
  ds_read_b64_tr_b16 v[34:35], v8 offset:33792
  ds_read_b128 v[96:99], v4 offset:16384
  s_waitcnt lgkmcnt(12)
  v_mfma_f32_32x32x16_bf16 v[144:159], v[36:39], v[108:111], v[144:159]
  ds_read_b128 v[100:103], v4 offset:20480
  s_waitcnt lgkmcnt(10)
  v_mfma_f32_32x32x16_bf16 v[128:143], v[40:43], v[112:115], v[128:143]
  ds_read_b64_tr_b16 v[36:37], v8 offset:36864
  ds_read_b64_tr_b16 v[38:39], v8 offset:37888
  ds_read_b128 v[104:107], v5 offset:16384
  s_waitcnt lgkmcnt(12)
  v_mfma_f32_32x32x16_bf16 v[144:159], v[40:43], v[116:119], v[144:159]
  ds_read_b128 v[108:111], v5 offset:20480
  s_waitcnt lgkmcnt(10)
  v_mfma_f32_32x32x16_bf16 v[128:143], v[44:47], v[120:123], v[128:143]
  ds_read_b64_tr_b16 v[40:41], v8 offset:40960
  ds_read_b64_tr_b16 v[42:43], v8 offset:41984
  ds_read_b128 v[112:115], v6 offset:16384
  s_waitcnt lgkmcnt(12)
  v_mfma_f32_32x32x16_bf16 v[144:159], v[44:47], v[124:127], v[144:159]
  ds_read_b128 v[116:119], v6 offset:20480
  s_waitcnt lgkmcnt(9)
  v_mfma_f32_32x32x16_bf16 v[128:143], v[32:35], v[96:99], v[128:143]
  ds_read_b64_tr_b16 v[44:45], v8 offset:45056
  ds_read_b64_tr_b16 v[46:47], v8 offset:46080
  ds_read_b128 v[120:123], v7 offset:16384
  s_waitcnt lgkmcnt(11)
  v_mfma_f32_32x32x16_bf16 v[144:159], v[32:35], v[100:103], v[144:159]
  ds_read_b128 v[124:127], v7 offset:20480
  v_mov_b32 v28, 9
  s_mov_b64 exec, 1
  ds_write_b32 v3, v28 offset:16
  s_mov_b64 exec, -1
  s_waitcnt lgkmcnt(10)
  v_mfma_f32_32x32x16_bf16 v[128:143], v[36:39], v[104:107], v[128:143]
  s_waitcnt lgkmcnt(9)
  v_mfma_f32_32x32x16_bf16 v[144:159], v[36:39], v[108:111], v[144:159]
  s_waitcnt lgkmcnt(6)
  v_mfma_f32_32x32x16_bf16 v[128:143], v[40:43], v[112:115], v[128:143]
  s_waitcnt lgkmcnt(5)
  v_mfma_f32_32x32x16_bf16 v[144:159], v[40:43], v[116:119], v[144:159]
  s_waitcnt lgkmcnt(2)
  v_mfma_f32_32x32x16_bf16 v[128:143], v[44:47], v[120:123], v[128:143]
  s_waitcnt lgkmcnt(1)
  v_mfma_f32_32x32x16_bf16 v[144:159], v[44:47], v[124:127], v[144:159]
  s_lshl_b32 s60, s56, 11
  s_add_u32 s60, s60, 16384
  v_add_u32 v20, s60, v27
  v_add_u32 v21, 0x4000, v17
  s_cmp_ge_u32 s94, 8
  s_cbranch_scc1 L_OK19
L_SP20:
  ds_read_b128 v[28:31], v2 offset:16
  s_waitcnt lgkmcnt(0)
  v_min3_u32 v28, v28, v29, v30
  v_min_u32 v28, v28, v31
  s_nop 0
  v_readfirstlane_b32 s94, v28
  s_add_i32 s93, s93, -1
  s_cmp_lt_i32 s93, 0
  s_cbranch_scc1 L_OK19
  s_cmp_ge_u32 s94, 8
  s_cbranch_scc0 L_SP20
L_OK19:
  s_nop 5
  v_cvt_pk_bf16_f32 v32, v128, v129
  v_cvt_pk_bf16_f32 v33, v130, v131
  v_cvt_pk_bf16_f32 v34, v132, v133
  v_cvt_pk_bf16_f32 v35, v134, v135
  v_cvt_pk_bf16_f32 v36, v136, v137
  v_cvt_pk_bf16_f32 v37, v138, v139
  v_cvt_pk_bf16_f32 v38, v140, v141
  v_cvt_pk_bf16_f32 v39, v142, v143
  ds_write_b128 v20, v[32:35] offset:0
  ds_write_b128 v20, v[36:39] offset:1024
  v_cvt_pk_bf16_f32 v40, v144, v145
  v_cvt_pk_bf16_f32 v41, v146, v147
  v_cvt_pk_bf16_f32 v42, v148, v149
  v_cvt_pk_bf16_f32 v43, v150, v151
  v_cvt_pk_bf16_f32 v44, v152, v153
  v_cvt_pk_bf16_f32 v45, v154, v155
  v_cvt_pk_bf16_f32 v46, v156, v157
  v_cvt_pk_bf16_f32 v47, v158, v159
  ds_write_b128 v20, v[40:43] offset:8192
  ds_write_b128 v20, v[44:47] offset:9216
  v_mov_b32 v28, 1
  s_mov_b64 exec, 1
  ds_write_b32 v3, v28 offset:32
  s_mov_b64 exec, -1
  v_mov_b32 v4, 0xff800000
  s_cmp_ge_u32 s92, 10
  s_cbranch_scc1 L_OK21
L_SP22:
  ds_read_b128 v[28:31], v2 offset:0
  s_waitcnt lgkmcnt(0)
  v_min3_u32 v28, v28, v29, v30
  v_min_u32 v28, v28, v31
  s_nop 0
  v_readfirstlane_b32 s92, v28
  s_add_i32 s93, s93, -1
  s_cmp_lt_i32 s93, 0
  s_cbranch_scc1 L_OK21
  s_cmp_ge_u32 s92, 10
  s_cbranch_scc0 L_SP22
L_OK21:
  v_add_u32 v22, 0xc000, v10
  ds_read_b128 v[96:99], v22 offset:0
  v_xor_b32 v24, 32, v22
  ds_read_b128 v[100:103], v24 offset:0
  v_xor_b32 v23, 64, v22
  ds_read_b128 v[104:107], v23 offset:0
  v_xor_b32 v24, 96, v22
  ds_read_b128 v[108:111], v24 offset:0
  v_xor_b32 v23, 128, v22
  ds_read_b128 v[112:115], v23 offset:0
  v_xor_b32 v24, 160, v22
  ds_read_b128 v[116:119], v24 offset:0
  v_xor_b32 v23, 192, v22
  ds_read_b128 v[120:123], v23 offset:0
  s_mov_b32 s63, 0
  s_cmp_ge_u32 s63, 1
  s_cbranch_scc1 L_OK23
L_SP24:
  ds_read_b128 v[28:31], v2 offset:32
  s_waitcnt lgkmcnt(0)
  v_min3_u32 v28, v28, v29, v30
  v_min_u32 v28, v28, v31
  s_nop 0
  v_readfirstlane_b32 s63, v28
  s_add_i32 s93, s93, -1
  s_cmp_lt_i32 s93, 0
  s_cbranch_scc1 L_OK23
  s_cmp_ge_u32 s63, 1
  s_cbranch_scc0 L_SP24
L_OK23:
  ds_read_b128 v[64:67], v21 offset:0
  ds_read_b128 v[68:71], v21 offset:1024
  ds_read_b128 v[72:75], v21 offset:2048
  ds_read_b128 v[76:79], v21 offset:3072
  ds_read_b128 v[80:83], v21 offset:4096
  ds_read_b128 v[84:87], v21 offset:5120
  ds_read_b128 v[88:91], v21 offset:6144
  ds_read_b128 v[92:95], v21 offset:7168
  v_mov_b32 v28, 10
  s_mov_b64 exec, 1
  ds_write_b32 v3, v28 offset:16
  s_mov_b64 exec, -1
  s_waitcnt lgkmcnt(15)
  s_waitcnt lgkmcnt(8)
  v_mfma_f32_32x32x16_bf16 v[128:143], v[96:99], v[64:67], 0
  v_xor_b32 v24, 224, v22
  ds_read_b128 v[124:127], v24 offset:0
  v_mov_b32 v28, 11
  s_mov_b64 exec, 1
  ds_write_b32 v3, v28 offset:16
  s_mov_b64 exec, -1
  s_waitcnt lgkmcnt(9)
  v_mfma_f32_32x32x16_bf16 v[128:143], v[100:103], v[68:71], v[128:143]
  s_cmp_ge_u32 s92, 11
  s_cbranch_scc1 L_OK25
L_SP26:
  ds_read_b128 v[28:31], v2 offset:0
  s_waitcnt lgkmcnt(0)
  v_min3_u32 v28, v28, v29, v30
  v_min_u32 v28, v28, v31
  s_nop 0
  v_readfirstlane_b32 s92, v28
  s_add_i32 s93, s93, -1
  s_cmp_lt_i32 s93, 0
  s_cbranch_scc1 L_OK25
  s_cmp_ge_u32 s92, 11
  s_cbranch_scc0 L_SP26
L_OK25:
  v_add_u32 v22, 0x10000, v10
  ds_read_b128 v[96:99], v22 offset:0
  s_waitcnt lgkmcnt(9)
  v_mfma_f32_32x32x16_bf16 v[128:143], v[104:107], v[72:75], v[128:143]
  v_xor_b32 v24, 32, v22
  ds_read_b128 v[100:103], v24 offset:0
  s_waitcnt lgkmcnt(9)
  v_mfma_f32_32x32x16_bf16 v[128:143], v[108:111], v[76:79], v[128:143]
  v_xor_b32 v23, 64, v22
  ds_read_b128 v[104:107], v23 offset:0
  s_waitcnt lgkmcnt(9)
  v_mfma_f32_32x32x16_bf16 v[128:143], v[112:115], v[80:83], v[128:143]
  v_xor_b32 v24, 96, v22
  ds_read_b128 v[108:111], v24 offset:0
  s_waitcnt lgkmcnt(9)
  v_mfma_f32_32x32x16_bf16 v[128:143], v[116:119], v[84:87], v[128:143]
  v_xor_b32 v23, 128, v22
  ds_read_b128 v[112:115], v23 offset:0
  s_waitcnt lgkmcnt(9)
  v_mfma_f32_32x32x16_bf16 v[128:143], v[120:123], v[88:91], v[128:143]
  v_xor_b32 v24, 160, v22
  ds_read_b128 v[116:119], v24 offset:0
  s_waitcnt lgkmcnt(7)
  v_mfma_f32_32x32x16_bf16 v[128:143], v[124:127], v[92:95], v[128:143]
  v_xor_b32 v23, 192, v22
  ds_read_b128 v[120:123], v23 offset:0
  s_waitcnt lgkmcnt(6)
  v_mfma_f32_32x32x16_bf16 v[144:159], v[96:99], v[64:67], 0
  v_xor_b32 v24, 224, v22
  ds_read_b128 v[124:127], v24 offset:0
  v_mov_b32 v28, 12
  s_mov_b64 exec, 1
  ds_write_b32 v3, v28 offset:16
  s_mov_b64 exec, -1
  s_waitcnt lgkmcnt(7)
  v_mfma_f32_32x32x16_bf16 v[144:159], v[100:103], v[68:71], v[144:159]
  s_cmp_ge_u32 s92, 12
  s_cbranch_scc1 L_OK27
L_SP28:
  ds_read_b128 v[28:31], v2 offset:0
  s_waitcnt lgkmcnt(0)
  v_min3_u32 v28, v28, v29, v30
  v_min_u32 v28, v28, v31
  s_nop 0
  v_readfirstlane_b32 s92, v28
  s_add_i32 s93, s93, -1
  s_cmp_lt_i32 s93, 0
  s_cbranch_scc1 L_OK27
  s_cmp_ge_u32 s92, 12
  s_cbranch_scc0 L_SP28
L_OK27:
  v_add_u32 v22, 0x1c000, v10
  ds_read_b128 v[96:99], v22 offset:0
  s_waitcnt lgkmcnt(7)
  v_mfma_f32_32x32x16_bf16 v[144:159], v[104:107], v[72:75], v[144:159]
  v_xor_b32 v24, 32, v22
  ds_read_b128 v[100:103], v24 offset:0
  s_waitcnt lgkmcnt(7)
  v_mfma_f32_32x32x16_bf16 v[144:159], v[108:111], v[76:79], v[144:159]
  v_max3_f32 v4, v128, v129, v4
  v_max3_f32 v4, v130, v131, v4
  v_xor_b32 v23, 64, v22
  ds_read_b128 v[104:107], v23 offset:0
  s_waitcnt lgkmcnt(7)
  v_mfma_f32_32x32x16_bf16 v[144:159], v[112:115], v[80:83], v[144:159]
  v_max3_f32 v4, v132, v133, v4
  v_max3_f32 v4, v134, v135, v4
  v_xor_b32 v24, 96, v22
  ds_read_b128 v[108:111], v24 offset:0
  s_waitcnt lgkmcnt(7)
  v_mfma_f32_32x32x16_bf16 v[144:159], v[116:119], v[84:87], v[144:159]
  v_max3_f32 v4, v136, v137, v4
  v_max3_f32 v4, v138, v139, v4
  v_xor_b32 v23, 128, v22
  ds_read_b128 v[112:115], v23 offset:0
  s_waitcnt lgkmcnt(7)
  v_mfma_f32_32x32x16_bf16 v[144:159], v[120:123], v[88:91], v[144:159]
  v_max3_f32 v4, v140, v141, v4
  v_max3_f32 v4, v142, v143, v4
  v_xor_b32 v24, 160, v22
  ds_read_b128 v[116:119], v24 offset:0
  s_waitcnt lgkmcnt(7)
  v_mfma_f32_32x32x16_bf16 v[144:159], v[124:127], v[92:95], v[144:159]
  v_xor_b32 v23, 192, v22
  ds_read_b128 v[120:123], v23 offset:0
  s_waitcnt lgkmcnt(6)
  v_mfma_f32_32x32x16_bf16 v[160:175], v[96:99], v[64:67], 0
  v_xor_b32 v24, 224, v22
  ds_read_b128 v[124:127], v24 offset:0
  v_mov_b32 v28, 13
  s_mov_b64 exec, 1
  ds_write_b32 v3, v28 offset:16
  s_mov_b64 exec, -1
  s_waitcnt lgkmcnt(7)
  v_mfma_f32_32x32x16_bf16 v[160:175], v[100:103], v[68:71], v[160:175]
  s_cmp_ge_u32 s92, 13
  s_cbranch_scc1 L_OK29
L_SP30:
  ds_read_b128 v[28:31], v2 offset:0
  s_waitcnt lgkmcnt(0)
  v_min3_u32 v28, v28, v29, v30
  v_min_u32 v28, v28, v31
  s_nop 0
  v_readfirstlane_b32 s92, v28
  s_add_i32 s93, s93, -1
  s_cmp_lt_i32 s93, 0
  s_cbranch_scc1 L_OK29
  s_cmp_ge_u32 s92, 13
  s_cbranch_scc0 L_SP30
L_OK29:
  v_add_u32 v22, 0x14000, v10
  ds_read_b128 v[96:99], v22 offset:0
  s_waitcnt lgkmcnt(7)
  v_mfma_f32_32x32x16_bf16 v[160:175], v[104:107], v[72:75], v[160:175]
  v_xor_b32 v24, 32, v22
  ds_read_b128 v[100:103], v24 offset:0
  s_waitcnt lgkmcnt(7)
  v_mfma_f32_32x32x16_bf16 v[160:175], v[108:111], v[76:79], v[160:175]
  v_max3_f32 v4, v144, v145, v4
  v_max3_f32 v4, v146, v147, v4
  v_xor_b32 v23, 64, v22
  ds_read_b128 v[104:107], v23 offset:0
  s_waitcnt lgkmcnt(7)
  v_mfma_f32_32x32x16_bf16 v[160:175], v[112:115], v[80:83], v[160:175]
  v_max3_f32 v4, v148, v149, v4
  v_max3_f32 v4, v150, v151, v4
  v_xor_b32 v24, 96, v22
  ds_read_b128 v[108:111], v24 offset:0
  s_waitcnt lgkmcnt(7)
  v_mfma_f32_32x32x16_bf16 v[160:175], v[116:119], v[84:87], v[160:175]
  v_max3_f32 v4, v152, v153, v4
  v_max3_f32 v4, v154, v155, v4
  v_xor_b32 v23, 128, v22
  ds_read_b128 v[112:115], v23 offset:0
  s_waitcnt lgkmcnt(7)
  v_mfma_f32_32x32x16_bf16 v[160:175], v[120:123], v[88:91], v[160:175]
  v_max3_f32 v4, v156, v157, v4
  v_max3_f32 v4, v158, v159, v4
  v_xor_b32 v24, 160, v22
  ds_read_b128 v[116:119], v24 offset:0
  s_waitcnt lgkmcnt(7)
  v_mfma_f32_32x32x16_bf16 v[160:175], v[124:127], v[92:95], v[160:175]
  v_xor_b32 v23, 192, v22
  ds_read_b128 v[120:123], v23 offset:0
  s_waitcnt lgkmcnt(6)
  v_mfma_f32_32x32x16_bf16 v[176:191], v[96:99], v[64:67], 0
  v_xor_b32 v24, 224, v22
  ds_read_b128 v[124:127], v24 offset:0
  v_mov_b32 v28, 14
  s_mov_b64 exec, 1
  ds_write_b32 v3, v28 offset:16
  s_mov_b64 exec, -1
  s_waitcnt lgkmcnt(7)
  v_mfma_f32_32x32x16_bf16 v[176:191], v[100:103], v[68:71], v[176:191]
  s_cmp_ge_u32 s92, 14
  s_cbranch_scc1 L_OK31
L_SP32:
  ds_read_b128 v[28:31], v2 offset:0
  s_waitcnt lgkmcnt(0)
  v_min3_u32 v28, v28, v29, v30
  v_min_u32 v28, v28, v31
  s_nop 0
  v_readfirstlane_b32 s92, v28
  s_add_i32 s93, s93, -1
  s_cmp_lt_i32 s93, 0
  s_cbranch_scc1 L_OK31
  s_cmp_ge_u32 s92, 14
  s_cbranch_scc0 L_SP32
L_OK31:
  v_add_u32 v22, 0x18000, v10
  ds_read_b128 v[96:99], v22 offset:0
  s_waitcnt lgkmcnt(7)
  v_mfma_f32_32x32x16_bf16 v[176:191], v[104:107], v[72:75], v[176:191]
  v_xor_b32 v24, 32, v22
  ds_read_b128 v[100:103], v24 offset:0
  s_waitcnt lgkmcnt(7)
  v_mfma_f32_32x32x16_bf16 v[176:191], v[108:111], v[76:79], v[176:191]
  v_max3_f32 v4, v160, v161, v4
  v_max3_f32 v4, v162, v163, v4
  v_xor_b32 v23, 64, v22
  ds_read_b128 v[104:107], v23 offset:0
  s_waitcnt lgkmcnt(7)
  v_mfma_f32_32x32x16_bf16 v[176:191], v[112:115], v[80:83], v[176:191]
  v_max3_f32 v4, v164, v165, v4
  v_max3_f32 v4, v166, v167, v4
  v_xor_b32 v24, 96, v22
  ds_read_b128 v[108:111], v24 offset:0
  s_waitcnt lgkmcnt(7)
  v_mfma_f32_32x32x16_bf16 v[176:191], v[116:119], v[84:87], v[176:191]
  v_max3_f32 v4, v168, v169, v4
  v_max3_f32 v4, v170, v171, v4
  v_xor_b32 v23, 128, v22
  ds_read_b128 v[112:115], v23 offset:0
  s_waitcnt lgkmcnt(7)
  v_mfma_f32_32x32x16_bf16 v[176:191], v[120:123], v[88:91], v[176:191]
  v_max3_f32 v4, v172, v173, v4
  v_max3_f32 v4, v174, v175, v4
  v_xor_b32 v24, 160, v22
  ds_read_b128 v[116:119], v24 offset:0
  s_waitcnt lgkmcnt(7)
  v_mfma_f32_32x32x16_bf16 v[176:191], v[124:127], v[92:95], v[176:191]
  v_xor_b32 v23, 192, v22
  ds_read_b128 v[120:123], v23 offset:0
  s_waitcnt lgkmcnt(6)
  v_mfma_f32_32x32x16_bf16 v[192:207], v[96:99], v[64:67], 0
  v_xor_b32 v24, 224, v22
  ds_read_b128 v[124:127], v24 offset:0
  v_mov_b32 v28, 15
  s_mov_b64 exec, 1
  ds_write_b32 v3, v28 offset:16
  s_mov_b64 exec, -1
  s_waitcnt lgkmcnt(7)
  v_mfma_f32_32x32x16_bf16 v[192:207], v[100:103], v[68:71], v[192:207]
  s_cmp_ge_u32 s92, 15
  s_cbranch_scc1 L_OK33
L_SP34:
  ds_read_b128 v[28:31], v2 offset:0
  s_waitcnt lgkmcnt(0)
  v_min3_u32 v28, v28, v29, v30
  v_min_u32 v28, v28, v31
  s_nop 0
  v_readfirstlane_b32 s92, v28
  s_add_i32 s93, s93, -1
  s_cmp_lt_i32 s93, 0
  s_cbranch_scc1 L_OK33
  s_cmp_ge_u32 s92, 15
  s_cbranch_scc0 L_SP34
L_OK33:
  v_add_u32 v22, 0x0, v10
  ds_read_b128 v[96:99], v22 offset:0
  s_waitcnt lgkmcnt(7)
  v_mfma_f32_32x32x16_bf16 v[192:207], v[104:107], v[72:75], v[192:207]
  v_xor_b32 v24, 32, v22
  ds_read_b128 v[100:103], v24 offset:0
  s_waitcnt lgkmcnt(7)
  v_mfma_f32_32x32x16_bf16 v[192:207], v[108:111], v[76:79], v[192:207]
  v_max3_f32 v4, v176, v177, v4
  v_max3_f32 v4, v178, v179, v4
  v_xor_b32 v23, 64, v22
  ds_read_b128 v[104:107], v23 offset:0
  s_waitcnt lgkmcnt(7)
  v_mfma_f32_32x32x16_bf16 v[192:207], v[112:115], v[80:83], v[192:207]
  v_max3_f32 v4, v180, v181, v4
  v_max3_f32 v4, v182, v183, v4
  v_xor_b32 v24, 96, v22
  ds_read_b128 v[108:111], v24 offset:0
  s_waitcnt lgkmcnt(7)
  v_mfma_f32_32x32x16_bf16 v[192:207], v[116:119], v[84:87], v[192:207]
  v_max3_f32 v4, v184, v185, v4
  v_max3_f32 v4, v186, v187, v4
  v_xor_b32 v23, 128, v22
  ds_read_b128 v[112:115], v23 offset:0
  s_waitcnt lgkmcnt(7)
  v_mfma_f32_32x32x16_bf16 v[192:207], v[120:123], v[88:91], v[192:207]
  v_max3_f32 v4, v188, v189, v4
  v_max3_f32 v4, v190, v191, v4
  v_xor_b32 v24, 160, v22
  ds_read_b128 v[116:119], v24 offset:0
  s_waitcnt lgkmcnt(7)
  v_mfma_f32_32x32x16_bf16 v[192:207], v[124:127], v[92:95], v[192:207]
  v_xor_b32 v23, 192, v22
  ds_read_b128 v[120:123], v23 offset:0
  s_waitcnt lgkmcnt(6)
  v_mfma_f32_32x32x16_bf16 v[208:223], v[96:99], v[64:67], 0
  v_xor_b32 v24, 224, v22
  ds_read_b128 v[124:127], v24 offset:0
  v_mov_b32 v28, 16
  s_mov_b64 exec, 1
  ds_write_b32 v3, v28 offset:16
  s_mov_b64 exec, -1
  s_waitcnt lgkmcnt(7)
  v_mfma_f32_32x32x16_bf16 v[208:223], v[100:103], v[68:71], v[208:223]
  s_cmp_ge_u32 s92, 16
  s_cbranch_scc1 L_OK35
L_SP36:
  ds_read_b128 v[28:31], v2 offset:0
  s_waitcnt lgkmcnt(0)
  v_min3_u32 v28, v28, v29, v30
  v_min_u32 v28, v28, v31
  s_nop 0
  v_readfirstlane_b32 s92, v28
  s_add_i32 s93, s93, -1
  s_cmp_lt_i32 s93, 0
  s_cbranch_scc1 L_OK35
  s_cmp_ge_u32 s92, 16
  s_cbranch_scc0 L_SP36
L_OK35:
  v_add_u32 v22, 0x8000, v10
  ds_read_b128 v[96:99], v22 offset:0
  s_waitcnt lgkmcnt(7)
  v_mfma_f32_32x32x16_bf16 v[208:223], v[104:107], v[72:75], v[208:223]
  v_xor_b32 v24, 32, v22
  ds_read_b128 v[100:103], v24 offset:0
  s_waitcnt lgkmcnt(7)
  v_mfma_f32_32x32x16_bf16 v[208:223], v[108:111], v[76:79], v[208:223]
  v_max3_f32 v4, v192, v193, v4
  v_max3_f32 v4, v194, v195, v4
  v_xor_b32 v23, 64, v22
  ds_read_b128 v[104:107], v23 offset:0
  s_waitcnt lgkmcnt(7)
  v_mfma_f32_32x32x16_bf16 v[208:223], v[112:115], v[80:83], v[208:223]
  v_max3_f32 v4, v196, v197, v4
  v_max3_f32 v4, v198, v199, v4
  v_xor_b32 v24, 96, v22
  ds_read_b128 v[108:111], v24 offset:0
  s_waitcnt lgkmcnt(7)
  v_mfma_f32_32x32x16_bf16 v[208:223], v[116:119], v[84:87], v[208:223]
  v_max3_f32 v4, v200, v201, v4
  v_max3_f32 v4, v202, v203, v4
  v_xor_b32 v23, 128, v22
  ds_read_b128 v[112:115], v23 offset:0
  s_waitcnt lgkmcnt(7)
  v_mfma_f32_32x32x16_bf16 v[208:223], v[120:123], v[88:91], v[208:223]
  v_max3_f32 v4, v204, v205, v4
  v_max3_f32 v4, v206, v207, v4
  v_xor_b32 v24, 160, v22
  ds_read_b128 v[116:119], v24 offset:0
  s_waitcnt lgkmcnt(7)
  v_mfma_f32_32x32x16_bf16 v[208:223], v[124:127], v[92:95], v[208:223]
  v_xor_b32 v23, 192, v22
  ds_read_b128 v[120:123], v23 offset:0
  s_waitcnt lgkmcnt(6)
  v_mfma_f32_32x32x16_bf16 v[224:239], v[96:99], v[64:67], 0
  v_xor_b32 v24, 224, v22
  ds_read_b128 v[124:127], v24 offset:0
  v_mov_b32 v28, 17
  s_mov_b64 exec, 1
  ds_write_b32 v3, v28 offset:16
  s_mov_b64 exec, -1
  s_waitcnt lgkmcnt(7)
  v_mfma_f32_32x32x16_bf16 v[224:239], v[100:103], v[68:71], v[224:239]
  s_cmp_ge_u32 s92, 17
  s_cbranch_scc1 L_OK37
L_SP38:
  ds_read_b128 v[28:31], v2 offset:0
  s_waitcnt lgkmcnt(0)
  v_min3_u32 v28, v28, v29, v30
  v_min_u32 v28, v28, v31
  s_nop 0
  v_readfirstlane_b32 s92, v28
  s_add_i32 s93, s93, -1
  s_cmp_lt_i32 s93, 0
  s_cbranch_scc1 L_OK37
  s_cmp_ge_u32 s92, 17
  s_cbranch_scc0 L_SP38
L_OK37:
  v_add_u32 v22, 0x20000, v10
  ds_read_b128 v[96:99], v22 offset:0
  s_waitcnt lgkmcnt(7)
  v_mfma_f32_32x32x16_bf16 v[224:239], v[104:107], v[72:75], v[224:239]
  v_xor_b32 v24, 32, v22
  ds_read_b128 v[100:103], v24 offset:0
  s_waitcnt lgkmcnt(7)
  v_mfma_f32_32x32x16_bf16 v[224:239], v[108:111], v[76:79], v[224:239]
  v_max3_f32 v4, v208, v209, v4
  v_max3_f32 v4, v210, v211, v4
  v_xor_b32 v23, 64, v22
  ds_read_b128 v[104:107], v23 offset:0
  s_waitcnt lgkmcnt(7)
  v_mfma_f32_32x32x16_bf16 v[224:239], v[112:115], v[80:83], v[224:239]
  v_max3_f32 v4, v212, v213, v4
  v_max3_f32 v4, v214, v215, v4
  v_xor_b32 v24, 96, v22
  ds_read_b128 v[108:111], v24 offset:0
  s_waitcnt lgkmcnt(7)
  v_mfma_f32_32x32x16_bf16 v[224:239], v[116:119], v[84:87], v[224:239]
  v_max3_f32 v4, v216, v217, v4
  v_max3_f32 v4, v218, v219, v4
  v_xor_b32 v23, 128, v22
  ds_read_b128 v[112:115], v23 offset:0
  s_waitcnt lgkmcnt(7)
  v_mfma_f32_32x32x16_bf16 v[224:239], v[120:123], v[88:91], v[224:239]
  v_max3_f32 v4, v220, v221, v4
  v_max3_f32 v4, v222, v223, v4
  v_xor_b32 v24, 160, v22
  ds_read_b128 v[116:119], v24 offset:0
  s_waitcnt lgkmcnt(7)
  v_mfma_f32_32x32x16_bf16 v[224:239], v[124:127], v[92:95], v[224:239]
  v_xor_b32 v23, 192, v22
  ds_read_b128 v[120:123], v23 offset:0
  s_waitcnt lgkmcnt(6)
  v_mfma_f32_32x32x16_bf16 v[240:255], v[96:99], v[64:67], 0
  v_xor_b32 v24, 224, v22
  ds_read_b128 v[124:127], v24 offset:0
  v_mov_b32 v28, 18
  s_mov_b64 exec, 1
  ds_write_b32 v3, v28 offset:16
  s_mov_b64 exec, -1
  s_waitcnt lgkmcnt(7)
  v_mfma_f32_32x32x16_bf16 v[240:255], v[100:103], v[68:71], v[240:255]
  s_waitcnt lgkmcnt(6)
  v_mfma_f32_32x32x16_bf16 v[240:255], v[104:107], v[72:75], v[240:255]
  s_waitcnt lgkmcnt(5)
  v_mfma_f32_32x32x16_bf16 v[240:255], v[108:111], v[76:79], v[240:255]
  v_max3_f32 v4, v224, v225, v4
  v_max3_f32 v4, v226, v227, v4
  s_waitcnt lgkmcnt(4)
  v_mfma_f32_32x32x16_bf16 v[240:255], v[112:115], v[80:83], v[240:255]
  v_max3_f32 v4, v228, v229, v4
  v_max3_f32 v4, v230, v231, v4
  s_waitcnt lgkmcnt(3)
  v_mfma_f32_32x32x16_bf16 v[240:255], v[116:119], v[84:87], v[240:255]
  v_max3_f32 v4, v232, v233, v4
  v_max3_f32 v4, v234, v235, v4
  s_waitcnt lgkmcnt(2)
  v_mfma_f32_32x32x16_bf16 v[240:255], v[120:123], v[88:91], v[240:255]
  v_max3_f32 v4, v236, v237, v4
  v_max3_f32 v4, v238, v239, v4
  s_waitcnt lgkmcnt(1)
  v_mfma_f32_32x32x16_bf16 v[240:255], v[124:127], v[92:95], v[240:255]
  s_waitcnt vmcnt(0)
  v_readfirstlane_b32 s58, v16
  s_lshl_b32 s60, s56, 8
  s_add_u32 s60, s60, 156672
  v_lshlrev_b32 v20, 2, v1
  v_add_u32 v20, s60, v20
  v_xor_b32 v21, 0x100, v20
  s_nop 7
  v_max3_f32 v4, v240, v241, v4
  v_max3_f32 v4, v242, v243, v4
  v_max3_f32 v4, v244, v245, v4
  v_max3_f32 v4, v246, v247, v4
  v_max3_f32 v4, v248, v249, v4
  v_max3_f32 v4, v250, v251, v4
  v_max3_f32 v4, v252, v253, v4
  v_max3_f32 v4, v254, v255, v4
  s_add_u32 s58, s58, 1
  v_mov_b32 v22, v4
  s_nop 1
  v_permlane32_swap_b32 v22, v4
  v_max_f32 v4, v22, v4
  ds_write_b32 v20, v4 offset:0
  v_mov_b32 v8, 0
  v_mov_b32 v9, 0
  v_mul_f32 v6, s64, v4
  v_sub_f32 v6, 0, v6
  v_mov_b32 v7, v6
  v_pk_fma_f32 v[128:129], v[128:129], s[64:65], v[6:7]
  v_pk_fma_f32 v[130:131], v[130:131], s[64:65], v[6:7]
  v_pk_fma_f32 v[132:133], v[132:133], s[64:65], v[6:7]
  v_pk_fma_f32 v[134:135], v[134:135], s[64:65], v[6:7]
  v_pk_fma_f32 v[136:137], v[136:137], s[64:65], v[6:7]
  v_pk_fma_f32 v[138:139], v[138:139], s[64:65], v[6:7]
  v_pk_fma_f32 v[140:141], v[140:141], s[64:65], v[6:7]
  v_pk_fma_f32 v[142:143], v[142:143], s[64:65], v[6:7]
  v_exp_f32 v128, v128
  v_exp_f32 v129, v129
  v_exp_f32 v130, v130
  v_exp_f32 v131, v131
  v_exp_f32 v132, v132
  v_exp_f32 v133, v133
  v_exp_f32 v134, v134
  v_exp_f32 v135, v135
  v_exp_f32 v136, v136
  v_exp_f32 v137, v137
  v_exp_f32 v138, v138
  v_exp_f32 v139, v139
  v_exp_f32 v140, v140
  v_exp_f32 v141, v141
  v_exp_f32 v142, v142
  v_exp_f32 v143, v143
  s_nop 0
  v_pk_add_f32 v[8:9], v[8:9], v[128:129]
  v_pk_add_f32 v[8:9], v[8:9], v[130:131]
  v_pk_add_f32 v[8:9], v[8:9], v[132:133]
  v_pk_add_f32 v[8:9], v[8:9], v[134:135]
  v_pk_add_f32 v[8:9], v[8:9], v[136:137]
  v_pk_add_f32 v[8:9], v[8:9], v[138:139]
  v_pk_add_f32 v[8:9], v[8:9], v[140:141]
  v_pk_add_f32 v[8:9], v[8:9], v[142:143]
  v_cvt_pk_bf16_f32 v128, v128, v129
  v_cvt_pk_bf16_f32 v129, v130, v131
  v_cvt_pk_bf16_f32 v130, v132, v133
  v_cvt_pk_bf16_f32 v131, v134, v135
  v_cvt_pk_bf16_f32 v132, v136, v137
  v_cvt_pk_bf16_f32 v133, v138, v139
  v_cvt_pk_bf16_f32 v134, v140, v141
  v_cvt_pk_bf16_f32 v135, v142, v143
  v_pk_fma_f32 v[144:145], v[144:145], s[64:65], v[6:7]
  v_pk_fma_f32 v[146:147], v[146:147], s[64:65], v[6:7]
  v_pk_fma_f32 v[148:149], v[148:149], s[64:65], v[6:7]
  v_pk_fma_f32 v[150:151], v[150:151], s[64:65], v[6:7]
  v_pk_fma_f32 v[152:153], v[152:153], s[64:65], v[6:7]
  v_pk_fma_f32 v[154:155], v[154:155], s[64:65], v[6:7]
  v_pk_fma_f32 v[156:157], v[156:157], s[64:65], v[6:7]
  v_pk_fma_f32 v[158:159], v[158:159], s[64:65], v[6:7]
  v_exp_f32 v144, v144
  v_exp_f32 v145, v145
  v_exp_f32 v146, v146
  v_exp_f32 v147, v147
  v_exp_f32 v148, v148
  v_exp_f32 v149, v149
  v_exp_f32 v150, v150
  v_exp_f32 v151, v151
  v_exp_f32 v152, v152
  v_exp_f32 v153, v153
  v_exp_f32 v154, v154
  v_exp_f32 v155, v155
  v_exp_f32 v156, v156
  v_exp_f32 v157, v157
  v_exp_f32 v158, v158
  v_exp_f32 v159, v159
  s_nop 0
  v_pk_add_f32 v[8:9], v[8:9], v[144:145]
  v_pk_add_f32 v[8:9], v[8:9], v[146:147]
  v_pk_add_f32 v[8:9], v[8:9], v[148:149]
  v_pk_add_f32 v[8:9], v[8:9], v[150:151]
  v_pk_add_f32 v[8:9], v[8:9], v[152:153]
  v_pk_add_f32 v[8:9], v[8:9], v[154:155]
  v_pk_add_f32 v[8:9], v[8:9], v[156:157]
  v_pk_add_f32 v[8:9], v[8:9], v[158:159]
  v_cvt_pk_bf16_f32 v144, v144, v145
  v_cvt_pk_bf16_f32 v145, v146, v147
  v_cvt_pk_bf16_f32 v146, v148, v149
  v_cvt_pk_bf16_f32 v147, v150, v151
  v_cvt_pk_bf16_f32 v148, v152, v153
  v_cvt_pk_bf16_f32 v149, v154, v155
  v_cvt_pk_bf16_f32 v150, v156, v157
  v_cvt_pk_bf16_f32 v151, v158, v159
  v_pk_fma_f32 v[160:161], v[160:161], s[64:65], v[6:7]
  v_pk_fma_f32 v[162:163], v[162:163], s[64:65], v[6:7]
  v_pk_fma_f32 v[164:165], v[164:165], s[64:65], v[6:7]
  v_pk_fma_f32 v[166:167], v[166:167], s[64:65], v[6:7]
  v_pk_fma_f32 v[168:169], v[168:169], s[64:65], v[6:7]
  v_pk_fma_f32 v[170:171], v[170:171], s[64:65], v[6:7]
  v_pk_fma_f32 v[172:173], v[172:173], s[64:65], v[6:7]
  v_pk_fma_f32 v[174:175], v[174:175], s[64:65], v[6:7]
  v_exp_f32 v160, v160
  v_exp_f32 v161, v161
  v_exp_f32 v162, v162
  v_exp_f32 v163, v163
  v_exp_f32 v164, v164
  v_exp_f32 v165, v165
  v_exp_f32 v166, v166
  v_exp_f32 v167, v167
  v_exp_f32 v168, v168
  v_exp_f32 v169, v169
  v_exp_f32 v170, v170
  v_exp_f32 v171, v171
  v_exp_f32 v172, v172
  v_exp_f32 v173, v173
  v_exp_f32 v174, v174
  v_exp_f32 v175, v175
  s_nop 0
  v_pk_add_f32 v[8:9], v[8:9], v[160:161]
  v_pk_add_f32 v[8:9], v[8:9], v[162:163]
  v_pk_add_f32 v[8:9], v[8:9], v[164:165]
  v_pk_add_f32 v[8:9], v[8:9], v[166:167]
  v_pk_add_f32 v[8:9], v[8:9], v[168:169]
  v_pk_add_f32 v[8:9], v[8:9], v[170:171]
  v_pk_add_f32 v[8:9], v[8:9], v[172:173]
  v_pk_add_f32 v[8:9], v[8:9], v[174:175]
  v_cvt_pk_bf16_f32 v160, v160, v161
  v_cvt_pk_bf16_f32 v161, v162, v163
  v_cvt_pk_bf16_f32 v162, v164, v165
  v_cvt_pk_bf16_f32 v163, v166, v167
  v_cvt_pk_bf16_f32 v164, v168, v169
  v_cvt_pk_bf16_f32 v165, v170, v171
  v_cvt_pk_bf16_f32 v166, v172, v173
  v_cvt_pk_bf16_f32 v167, v174, v175
  v_pk_fma_f32 v[176:177], v[176:177], s[64:65], v[6:7]
  v_pk_fma_f32 v[178:179], v[178:179], s[64:65], v[6:7]
  v_pk_fma_f32 v[180:181], v[180:181], s[64:65], v[6:7]
  v_pk_fma_f32 v[182:183], v[182:183], s[64:65], v[6:7]
  v_pk_fma_f32 v[184:185], v[184:185], s[64:65], v[6:7]
  v_pk_fma_f32 v[186:187], v[186:187], s[64:65], v[6:7]
  v_pk_fma_f32 v[188:189], v[188:189], s[64:65], v[6:7]
  v_pk_fma_f32 v[190:191], v[190:191], s[64:65], v[6:7]
  v_exp_f32 v176, v176
  v_exp_f32 v177, v177
  v_exp_f32 v178, v178
  v_exp_f32 v179, v179
  v_exp_f32 v180, v180
  v_exp_f32 v181, v181
  v_exp_f32 v182, v182
  v_exp_f32 v183, v183
  v_exp_f32 v184, v184
  v_exp_f32 v185, v185
  v_exp_f32 v186, v186
  v_exp_f32 v187, v187
  v_exp_f32 v188, v188
  v_exp_f32 v189, v189
  v_exp_f32 v190, v190
  v_exp_f32 v191, v191
  s_nop 0
  v_pk_add_f32 v[8:9], v[8:9], v[176:177]
  v_pk_add_f32 v[8:9], v[8:9], v[178:179]
  v_pk_add_f32 v[8:9], v[8:9], v[180:181]
  v_pk_add_f32 v[8:9], v[8:9], v[182:183]
  v_pk_add_f32 v[8:9], v[8:9], v[184:185]
  v_pk_add_f32 v[8:9], v[8:9], v[186:187]
  v_pk_add_f32 v[8:9], v[8:9], v[188:189]
  v_pk_add_f32 v[8:9], v[8:9], v[190:191]
  v_cvt_pk_bf16_f32 v176, v176, v177
  v_cvt_pk_bf16_f32 v177, v178, v179
  v_cvt_pk_bf16_f32 v178, v180, v181
  v_cvt_pk_bf16_f32 v179, v182, v183
  v_cvt_pk_bf16_f32 v180, v184, v185
  v_cvt_pk_bf16_f32 v181, v186, v187
  v_cvt_pk_bf16_f32 v182, v188, v189
  v_cvt_pk_bf16_f32 v183, v190, v191
  v_pk_fma_f32 v[192:193], v[192:193], s[64:65], v[6:7]
  v_pk_fma_f32 v[194:195], v[194:195], s[64:65], v[6:7]
  v_pk_fma_f32 v[196:197], v[196:197], s[64:65], v[6:7]
  v_pk_fma_f32 v[198:199], v[198:199], s[64:65], v[6:7]
  v_pk_fma_f32 v[200:201], v[200:201], s[64:65], v[6:7]
  v_pk_fma_f32 v[202:203], v[202:203], s[64:65], v[6:7]
  v_pk_fma_f32 v[204:205], v[204:205], s[64:65], v[6:7]
  v_pk_fma_f32 v[206:207], v[206:207], s[64:65], v[6:7]
  v_exp_f32 v192, v192
  v_exp_f32 v193, v193
  v_exp_f32 v194, v194
  v_exp_f32 v195, v195
  v_exp_f32 v196, v196
  v_exp_f32 v197, v197
  v_exp_f32 v198, v198
  v_exp_f32 v199, v199
  v_exp_f32 v200, v200
  v_exp_f32 v201, v201
  v_exp_f32 v202, v202
  v_exp_f32 v203, v203
  v_exp_f32 v204, v204
  v_exp_f32 v205, v205
  v_exp_f32 v206, v206
  v_exp_f32 v207, v207
  s_nop 0
  v_pk_add_f32 v[8:9], v[8:9], v[192:193]
  v_pk_add_f32 v[8:9], v[8:9], v[194:195]
  v_pk_add_f32 v[8:9], v[8:9], v[196:197]
  v_pk_add_f32 v[8:9], v[8:9], v[198:199]
  v_pk_add_f32 v[8:9], v[8:9], v[200:201]
  v_pk_add_f32 v[8:9], v[8:9], v[202:203]
  v_pk_add_f32 v[8:9], v[8:9], v[204:205]
  v_pk_add_f32 v[8:9], v[8:9], v[206:207]
  v_cvt_pk_bf16_f32 v192, v192, v193
  v_cvt_pk_bf16_f32 v193, v194, v195
  v_cvt_pk_bf16_f32 v194, v196, v197
  v_cvt_pk_bf16_f32 v195, v198, v199
  v_cvt_pk_bf16_f32 v196, v200, v201
  v_cvt_pk_bf16_f32 v197, v202, v203
  v_cvt_pk_bf16_f32 v198, v204, v205
  v_cvt_pk_bf16_f32 v199, v206, v207
  v_pk_fma_f32 v[208:209], v[208:209], s[64:65], v[6:7]
  v_pk_fma_f32 v[210:211], v[210:211], s[64:65], v[6:7]
  v_pk_fma_f32 v[212:213], v[212:213], s[64:65], v[6:7]
  v_pk_fma_f32 v[214:215], v[214:215], s[64:65], v[6:7]
  v_pk_fma_f32 v[216:217], v[216:217], s[64:65], v[6:7]
  v_pk_fma_f32 v[218:219], v[218:219], s[64:65], v[6:7]
  v_pk_fma_f32 v[220:221], v[220:221], s[64:65], v[6:7]
  v_pk_fma_f32 v[222:223], v[222:223], s[64:65], v[6:7]
  v_exp_f32 v208, v208
  v_exp_f32 v209, v209
  v_exp_f32 v210, v210
  v_exp_f32 v211, v211
  v_exp_f32 v212, v212
  v_exp_f32 v213, v213
  v_exp_f32 v214, v214
  v_exp_f32 v215, v215
  v_exp_f32 v216, v216
  v_exp_f32 v217, v217
  v_exp_f32 v218, v218
  v_exp_f32 v219, v219
  v_exp_f32 v220, v220
  v_exp_f32 v221, v221
  v_exp_f32 v222, v222
  v_exp_f32 v223, v223
  s_nop 0
  v_pk_add_f32 v[8:9], v[8:9], v[208:209]
  v_pk_add_f32 v[8:9], v[8:9], v[210:211]
  v_pk_add_f32 v[8:9], v[8:9], v[212:213]
  v_pk_add_f32 v[8:9], v[8:9], v[214:215]
  v_pk_add_f32 v[8:9], v[8:9], v[216:217]
  v_pk_add_f32 v[8:9], v[8:9], v[218:219]
  v_pk_add_f32 v[8:9], v[8:9], v[220:221]
  v_pk_add_f32 v[8:9], v[8:9], v[222:223]
  v_cvt_pk_bf16_f32 v208, v208, v209
  v_cvt_pk_bf16_f32 v209, v210, v211
  v_cvt_pk_bf16_f32 v210, v212, v213
  v_cvt_pk_bf16_f32 v211, v214, v215
  v_cvt_pk_bf16_f32 v212, v216, v217
  v_cvt_pk_bf16_f32 v213, v218, v219
  v_cvt_pk_bf16_f32 v214, v220, v221
  v_cvt_pk_bf16_f32 v215, v222, v223
  v_pk_fma_f32 v[224:225], v[224:225], s[64:65], v[6:7]
  v_pk_fma_f32 v[226:227], v[226:227], s[64:65], v[6:7]
  v_pk_fma_f32 v[228:229], v[228:229], s[64:65], v[6:7]
  v_pk_fma_f32 v[230:231], v[230:231], s[64:65], v[6:7]
  v_pk_fma_f32 v[232:233], v[232:233], s[64:65], v[6:7]
  v_pk_fma_f32 v[234:235], v[234:235], s[64:65], v[6:7]
  v_pk_fma_f32 v[236:237], v[236:237], s[64:65], v[6:7]
  v_pk_fma_f32 v[238:239], v[238:239], s[64:65], v[6:7]
  v_exp_f32 v224, v224
  v_exp_f32 v225, v225
  v_exp_f32 v226, v226
  v_exp_f32 v227, v227
  v_exp_f32 v228, v228
  v_exp_f32 v229, v229
  v_exp_f32 v230, v230
  v_exp_f32 v231, v231
  v_exp_f32 v232, v232
  v_exp_f32 v233, v233
  v_exp_f32 v234, v234
  v_exp_f32 v235, v235
  v_exp_f32 v236, v236
  v_exp_f32 v237, v237
  v_exp_f32 v238, v238
  v_exp_f32 v239, v239
  s_nop 0
  v_pk_add_f32 v[8:9], v[8:9], v[224:225]
  v_pk_add_f32 v[8:9], v[8:9], v[226:227]
  v_pk_add_f32 v[8:9], v[8:9], v[228:229]
  v_pk_add_f32 v[8:9], v[8:9], v[230:231]
  v_pk_add_f32 v[8:9], v[8:9], v[232:233]
  v_pk_add_f32 v[8:9], v[8:9], v[234:235]
  v_pk_add_f32 v[8:9], v[8:9], v[236:237]
  v_pk_add_f32 v[8:9], v[8:9], v[238:239]
  v_cvt_pk_bf16_f32 v224, v224, v225
  v_cvt_pk_bf16_f32 v225, v226, v227
  v_cvt_pk_bf16_f32 v226, v228, v229
  v_cvt_pk_bf16_f32 v227, v230, v231
  v_cvt_pk_bf16_f32 v228, v232, v233
  v_cvt_pk_bf16_f32 v229, v234, v235
  v_cvt_pk_bf16_f32 v230, v236, v237
  v_cvt_pk_bf16_f32 v231, v238, v239
  v_pk_fma_f32 v[240:241], v[240:241], s[64:65], v[6:7]
  v_pk_fma_f32 v[242:243], v[242:243], s[64:65], v[6:7]
  v_pk_fma_f32 v[244:245], v[244:245], s[64:65], v[6:7]
  v_pk_fma_f32 v[246:247], v[246:247], s[64:65], v[6:7]
  v_pk_fma_f32 v[248:249], v[248:249], s[64:65], v[6:7]
  v_pk_fma_f32 v[250:251], v[250:251], s[64:65], v[6:7]
  v_pk_fma_f32 v[252:253], v[252:253], s[64:65], v[6:7]
  v_pk_fma_f32 v[254:255], v[254:255], s[64:65], v[6:7]
  v_exp_f32 v240, v240
  v_exp_f32 v241, v241
  v_exp_f32 v242, v242
  v_exp_f32 v243, v243
  v_exp_f32 v244, v244
  v_exp_f32 v245, v245
  v_exp_f32 v246, v246
  v_exp_f32 v247, v247
  v_exp_f32 v248, v248
  v_exp_f32 v249, v249
  v_exp_f32 v250, v250
  v_exp_f32 v251, v251
  v_exp_f32 v252, v252
  v_exp_f32 v253, v253
  v_exp_f32 v254, v254
  v_exp_f32 v255, v255
  s_nop 0
  v_pk_add_f32 v[8:9], v[8:9], v[240:241]
  v_pk_add_f32 v[8:9], v[8:9], v[242:243]
  v_pk_add_f32 v[8:9], v[8:9], v[244:245]
  v_pk_add_f32 v[8:9], v[8:9], v[246:247]
  v_pk_add_f32 v[8:9], v[8:9], v[248:249]
  v_pk_add_f32 v[8:9], v[8:9], v[250:251]
  v_pk_add_f32 v[8:9], v[8:9], v[252:253]
  v_pk_add_f32 v[8:9], v[8:9], v[254:255]
  v_cvt_pk_bf16_f32 v240, v240, v241
  v_cvt_pk_bf16_f32 v241, v242, v243
  v_cvt_pk_bf16_f32 v242, v244, v245
  v_cvt_pk_bf16_f32 v243, v246, v247
  v_cvt_pk_bf16_f32 v244, v248, v249
  v_cvt_pk_bf16_f32 v245, v250, v251
  v_cvt_pk_bf16_f32 v246, v252, v253
  v_cvt_pk_bf16_f32 v247, v254, v255
  v_add_f32 v5, v8, v9
  v_mov_b32 v22, v5
  s_nop 1
  v_permlane32_swap_b32 v22, v5
  v_add_f32 v5, v22, v5
  ds_write_b32 v20, v5 offset:1024
  s_cmp_ge_u32 s92, 18
  s_cbranch_scc1 L_OK39
L_SP40:
  ds_read_b128 v[28:31], v2 offset:0
  s_waitcnt lgkmcnt(0)
  v_min3_u32 v28, v28, v29, v30
  v_min_u32 v28, v28, v31
  s_nop 0
  v_readfirstlane_b32 s92, v28
  s_add_i32 s93, s93, -1
  s_cmp_lt_i32 s93, 0
  s_cbranch_scc1 L_OK39
  s_cmp_ge_u32 s92, 18
  s_cbranch_scc0 L_SP40
L_OK39:
  v_add_u32 v22, 0x4000, v11
  v_add_u32 v23, 0x4000, v12
  v_add_u32 v24, 0x4000, v13
  v_add_u32 v25, 0x4000, v14
  ds_read_b64_tr_b16 v[32:33], v22 offset:0
  ds_read_b64_tr_b16 v[34:35], v22 offset:2048
  ds_read_b64_tr_b16 v[36:37], v23 offset:0
  ds_read_b64_tr_b16 v[38:39], v23 offset:2048
  ds_read_b64_tr_b16 v[40:41], v24 offset:0
  ds_read_b64_tr_b16 v[42:43], v24 offset:2048
  ds_read_b64_tr_b16 v[44:45], v25 offset:0
  ds_read_b64_tr_b16 v[46:47], v25 offset:2048
  ds_read_b64_tr_b16 v[48:49], v22 offset:4096
  ds_read_b64_tr_b16 v[50:51], v22 offset:6144
  ds_read_b64_tr_b16 v[52:53], v23 offset:4096
  ds_read_b64_tr_b16 v[54:55], v23 offset:6144
  ds_read_b64_tr_b16 v[56:57], v24 offset:4096
  ds_read_b64_tr_b16 v[58:59], v24 offset:6144
  s_waitcnt lgkmcnt(12)
  v_mfma_f32_32x32x16_bf16 v[64:79], v[32:35], v[128:131], 0
  ds_read_b64_tr_b16 v[60:61], v25 offset:4096
  ds_read_b64_tr_b16 v[62:63], v25 offset:6144
  v_mov_b32 v28, 19
  s_mov_b64 exec, 1
  ds_write_b32 v3, v28 offset:16
  s_mov_b64 exec, -1
  s_waitcnt lgkmcnt(13)
  v_mfma_f32_32x32x16_bf16 v[80:95], v[36:39], v[128:131], 0
  s_cmp_ge_u32 s92, 19
  s_cbranch_scc1 L_OK41
L_SP42:
  ds_read_b128 v[28:31], v2 offset:0
  s_waitcnt lgkmcnt(0)
  v_min3_u32 v28, v28, v29, v30
  v_min_u32 v28, v28, v31
  s_nop 0
  v_readfirstlane_b32 s92, v28
  s_add_i32 s93, s93, -1
  s_cmp_lt_i32 s93, 0
  s_cbranch_scc1 L_OK41
  s_cmp_ge_u32 s92, 19
  s_cbranch_scc0 L_SP42
L_OK41:
  v_add_u32 v22, 0xc000, v11
  v_add_u32 v23, 0xc000, v12
  v_add_u32 v24, 0xc000, v13
  v_add_u32 v25, 0xc000, v14
  ds_read_b64_tr_b16 v[32:33], v22 offset:0
  ds_read_b64_tr_b16 v[34:35], v22 offset:2048
  s_waitcnt lgkmcnt(13)
  v_mfma_f32_32x32x16_bf16 v[96:111], v[40:43], v[128:131], 0
  ds_read_b64_tr_b16 v[36:37], v23 offset:0
  ds_read_b64_tr_b16 v[38:39], v23 offset:2048
  s_waitcnt lgkmcnt(13)
  v_mfma_f32_32x32x16_bf16 v[112:127], v[44:47], v[128:131], 0
  ds_read_b64_tr_b16 v[40:41], v24 offset:0
  ds_read_b64_tr_b16 v[42:43], v24 offset:2048
  s_waitcnt lgkmcnt(13)
  v_mfma_f32_32x32x16_bf16 v[64:79], v[48:51], v[132:135], v[64:79]
  ds_read_b64_tr_b16 v[44:45], v25 offset:0
  ds_read_b64_tr_b16 v[46:47], v25 offset:2048
  s_waitcnt lgkmcnt(13)
  v_mfma_f32_32x32x16_bf16 v[80:95], v[52:55], v[132:135], v[80:95]
  ds_read_b64_tr_b16 v[48:49], v22 offset:4096
  ds_read_b64_tr_b16 v[50:51], v22 offset:6144
  s_waitcnt lgkmcnt(13)
  v_mfma_f32_32x32x16_bf16 v[96:111], v[56:59], v[132:135], v[96:111]
  ds_read_b64_tr_b16 v[52:53], v23 offset:4096
  ds_read_b64_tr_b16 v[54:55], v23 offset:6144
  s_waitcnt lgkmcnt(13)
  v_mfma_f32_32x32x16_bf16 v[112:127], v[60:63], v[132:135], v[112:127]
  ds_read_b64_tr_b16 v[56:57], v24 offset:4096
  ds_read_b64_tr_b16 v[58:59], v24 offset:6144
  s_waitcnt lgkmcnt(12)
  v_mfma_f32_32x32x16_bf16 v[64:79], v[32:35], v[144:147], v[64:79]
  ds_read_b64_tr_b16 v[60:61], v25 offset:4096
  ds_read_b64_tr_b16 v[62:63], v25 offset:6144
  v_mov_b32 v28, 20
  s_mov_b64 exec, 1
  ds_write_b32 v3, v28 offset:16
  s_mov_b64 exec, -1
  s_waitcnt lgkmcnt(13)
  v_mfma_f32_32x32x16_bf16 v[80:95], v[36:39], v[144:147], v[80:95]
  s_cmp_ge_u32 s92, 20
  s_cbranch_scc1 L_OK43
L_SP44:
  ds_read_b128 v[28:31], v2 offset:0
  s_waitcnt lgkmcnt(0)
  v_min3_u32 v28, v28, v29, v30
  v_min_u32 v28, v28, v31
  s_nop 0
  v_readfirstlane_b32 s92, v28
  s_add_i32 s93, s93, -1
  s_cmp_lt_i32 s93, 0
  s_cbranch_scc1 L_OK43
  s_cmp_ge_u32 s92, 20
  s_cbranch_scc0 L_SP44
L_OK43:
  v_add_u32 v22, 0x10000, v11
  v_add_u32 v23, 0x10000, v12
  v_add_u32 v24, 0x10000, v13
  v_add_u32 v25, 0x10000, v14
  ds_read_b64_tr_b16 v[32:33], v22 offset:0
  ds_read_b64_tr_b16 v[34:35], v22 offset:2048
  s_waitcnt lgkmcnt(13)
  v_mfma_f32_32x32x16_bf16 v[96:111], v[40:43], v[144:147], v[96:111]
  ds_read_b64_tr_b16 v[36:37], v23 offset:0
  ds_read_b64_tr_b16 v[38:39], v23 offset:2048
  s_waitcnt lgkmcnt(13)
  v_mfma_f32_32x32x16_bf16 v[112:127], v[44:47], v[144:147], v[112:127]
  ds_read_b64_tr_b16 v[40:41], v24 offset:0
  ds_read_b64_tr_b16 v[42:43], v24 offset:2048
  s_waitcnt lgkmcnt(13)
  v_mfma_f32_32x32x16_bf16 v[64:79], v[48:51], v[148:151], v[64:79]
  ds_read_b64_tr_b16 v[44:45], v25 offset:0
  ds_read_b64_tr_b16 v[46:47], v25 offset:2048
  s_waitcnt lgkmcnt(13)
  v_mfma_f32_32x32x16_bf16 v[80:95], v[52:55], v[148:151], v[80:95]
  ds_read_b64_tr_b16 v[48:49], v22 offset:4096
  ds_read_b64_tr_b16 v[50:51], v22 offset:6144
  s_waitcnt lgkmcnt(13)
  v_mfma_f32_32x32x16_bf16 v[96:111], v[56:59], v[148:151], v[96:111]
  ds_read_b64_tr_b16 v[52:53], v23 offset:4096
  ds_read_b64_tr_b16 v[54:55], v23 offset:6144
  s_waitcnt lgkmcnt(13)
  v_mfma_f32_32x32x16_bf16 v[112:127], v[60:63], v[148:151], v[112:127]
  ds_read_b64_tr_b16 v[56:57], v24 offset:4096
  ds_read_b64_tr_b16 v[58:59], v24 offset:6144
  s_waitcnt lgkmcnt(12)
  v_mfma_f32_32x32x16_bf16 v[64:79], v[32:35], v[160:163], v[64:79]
  ds_read_b64_tr_b16 v[60:61], v25 offset:4096
  ds_read_b64_tr_b16 v[62:63], v25 offset:6144
  v_mov_b32 v28, 21
  s_mov_b64 exec, 1
  ds_write_b32 v3, v28 offset:16
  s_mov_b64 exec, -1
  s_waitcnt lgkmcnt(13)
  v_mfma_f32_32x32x16_bf16 v[80:95], v[36:39], v[160:163], v[80:95]
  s_cmp_ge_u32 s92, 21
  s_cbranch_scc1 L_OK45
L_SP46:
  ds_read_b128 v[28:31], v2 offset:0
  s_waitcnt lgkmcnt(0)
  v_min3_u32 v28, v28, v29, v30
  v_min_u32 v28, v28, v31
  s_nop 0
  v_readfirstlane_b32 s92, v28
  s_add_i32 s93, s93, -1
  s_cmp_lt_i32 s93, 0
  s_cbranch_scc1 L_OK45
  s_cmp_ge_u32 s92, 21
  s_cbranch_scc0 L_SP46
L_OK45:
  v_add_u32 v22, 0x1c000, v11
  v_add_u32 v23, 0x1c000, v12
  v_add_u32 v24, 0x1c000, v13
  v_add_u32 v25, 0x1c000, v14
  ds_read_b64_tr_b16 v[32:33], v22 offset:0
  ds_read_b64_tr_b16 v[34:35], v22 offset:2048
  s_waitcnt lgkmcnt(13)
  v_mfma_f32_32x32x16_bf16 v[96:111], v[40:43], v[160:163], v[96:111]
  ds_read_b64_tr_b16 v[36:37], v23 offset:0
  ds_read_b64_tr_b16 v[38:39], v23 offset:2048
  s_waitcnt lgkmcnt(13)
  v_mfma_f32_32x32x16_bf16 v[112:127], v[44:47], v[160:163], v[112:127]
  ds_read_b64_tr_b16 v[40:41], v24 offset:0
  ds_read_b64_tr_b16 v[42:43], v24 offset:2048
  s_waitcnt lgkmcnt(13)
  v_mfma_f32_32x32x16_bf16 v[64:79], v[48:51], v[164:167], v[64:79]
  ds_read_b64_tr_b16 v[44:45], v25 offset:0
  ds_read_b64_tr_b16 v[46:47], v25 offset:2048
  s_waitcnt lgkmcnt(13)
  v_mfma_f32_32x32x16_bf16 v[80:95], v[52:55], v[164:167], v[80:95]
  ds_read_b64_tr_b16 v[48:49], v22 offset:4096
  ds_read_b64_tr_b16 v[50:51], v22 offset:6144
  s_waitcnt lgkmcnt(13)
  v_mfma_f32_32x32x16_bf16 v[96:111], v[56:59], v[164:167], v[96:111]
  ds_read_b64_tr_b16 v[52:53], v23 offset:4096
  ds_read_b64_tr_b16 v[54:55], v23 offset:6144
  s_waitcnt lgkmcnt(13)
  v_mfma_f32_32x32x16_bf16 v[112:127], v[60:63], v[164:167], v[112:127]
  ds_read_b64_tr_b16 v[56:57], v24 offset:4096
  ds_read_b64_tr_b16 v[58:59], v24 offset:6144
  s_waitcnt lgkmcnt(12)
  v_mfma_f32_32x32x16_bf16 v[64:79], v[32:35], v[176:179], v[64:79]
  ds_read_b64_tr_b16 v[60:61], v25 offset:4096
  ds_read_b64_tr_b16 v[62:63], v25 offset:6144
  v_mov_b32 v28, 22
  s_mov_b64 exec, 1
  ds_write_b32 v3, v28 offset:16
  s_mov_b64 exec, -1
  s_waitcnt lgkmcnt(13)
  v_mfma_f32_32x32x16_bf16 v[80:95], v[36:39], v[176:179], v[80:95]
  s_cmp_ge_u32 s92, 22
  s_cbranch_scc1 L_OK47
L_SP48:
  ds_read_b128 v[28:31], v2 offset:0
  s_waitcnt lgkmcnt(0)
  v_min3_u32 v28, v28, v29, v30
  v_min_u32 v28, v28, v31
  s_nop 0
  v_readfirstlane_b32 s92, v28
  s_add_i32 s93, s93, -1
  s_cmp_lt_i32 s93, 0
  s_cbranch_scc1 L_OK47
  s_cmp_ge_u32 s92, 22
  s_cbranch_scc0 L_SP48
L_OK47:
  v_add_u32 v22, 0x14000, v11
  v_add_u32 v23, 0x14000, v12
  v_add_u32 v24, 0x14000, v13
  v_add_u32 v25, 0x14000, v14
  ds_read_b64_tr_b16 v[32:33], v22 offset:0
  ds_read_b64_tr_b16 v[34:35], v22 offset:2048
  s_waitcnt lgkmcnt(13)
  v_mfma_f32_32x32x16_bf16 v[96:111], v[40:43], v[176:179], v[96:111]
  ds_read_b64_tr_b16 v[36:37], v23 offset:0
  ds_read_b64_tr_b16 v[38:39], v23 offset:2048
  s_waitcnt lgkmcnt(13)
  v_mfma_f32_32x32x16_bf16 v[112:127], v[44:47], v[176:179], v[112:127]
  ds_read_b64_tr_b16 v[40:41], v24 offset:0
  ds_read_b64_tr_b16 v[42:43], v24 offset:2048
  s_waitcnt lgkmcnt(13)
  v_mfma_f32_32x32x16_bf16 v[64:79], v[48:51], v[180:183], v[64:79]
  ds_read_b64_tr_b16 v[44:45], v25 offset:0
  ds_read_b64_tr_b16 v[46:47], v25 offset:2048
  s_waitcnt lgkmcnt(13)
  v_mfma_f32_32x32x16_bf16 v[80:95], v[52:55], v[180:183], v[80:95]
  ds_read_b64_tr_b16 v[48:49], v22 offset:4096
  ds_read_b64_tr_b16 v[50:51], v22 offset:6144
  s_waitcnt lgkmcnt(13)
  v_mfma_f32_32x32x16_bf16 v[96:111], v[56:59], v[180:183], v[96:111]
  ds_read_b64_tr_b16 v[52:53], v23 offset:4096
  ds_read_b64_tr_b16 v[54:55], v23 offset:6144
  s_waitcnt lgkmcnt(13)
  v_mfma_f32_32x32x16_bf16 v[112:127], v[60:63], v[180:183], v[112:127]
  ds_read_b64_tr_b16 v[56:57], v24 offset:4096
  ds_read_b64_tr_b16 v[58:59], v24 offset:6144
  s_waitcnt lgkmcnt(12)
  v_mfma_f32_32x32x16_bf16 v[64:79], v[32:35], v[192:195], v[64:79]
  ds_read_b64_tr_b16 v[60:61], v25 offset:4096
  ds_read_b64_tr_b16 v[62:63], v25 offset:6144
  v_mov_b32 v28, 23
  s_mov_b64 exec, 1
  ds_write_b32 v3, v28 offset:16
  s_mov_b64 exec, -1
  s_waitcnt lgkmcnt(13)
  v_mfma_f32_32x32x16_bf16 v[80:95], v[36:39], v[192:195], v[80:95]
  s_cmp_ge_u32 s92, 23
  s_cbranch_scc1 L_OK49
L_SP50:
  ds_read_b128 v[28:31], v2 offset:0
  s_waitcnt lgkmcnt(0)
  v_min3_u32 v28, v28, v29, v30
  v_min_u32 v28, v28, v31
  s_nop 0
  v_readfirstlane_b32 s92, v28
  s_add_i32 s93, s93, -1
  s_cmp_lt_i32 s93, 0
  s_cbranch_scc1 L_OK49
  s_cmp_ge_u32 s92, 23
  s_cbranch_scc0 L_SP50
L_OK49:
  v_add_u32 v22, 0x18000, v11
  v_add_u32 v23, 0x18000, v12
  v_add_u32 v24, 0x18000, v13
  v_add_u32 v25, 0x18000, v14
  ds_read_b64_tr_b16 v[32:33], v22 offset:0
  ds_read_b64_tr_b16 v[34:35], v22 offset:2048
  s_waitcnt lgkmcnt(13)
  v_mfma_f32_32x32x16_bf16 v[96:111], v[40:43], v[192:195], v[96:111]
  ds_read_b64_tr_b16 v[36:37], v23 offset:0
  ds_read_b64_tr_b16 v[38:39], v23 offset:2048
  s_waitcnt lgkmcnt(13)
  v_mfma_f32_32x32x16_bf16 v[112:127], v[44:47], v[192:195], v[112:127]
  ds_read_b64_tr_b16 v[40:41], v24 offset:0
  ds_read_b64_tr_b16 v[42:43], v24 offset:2048
  s_waitcnt lgkmcnt(13)
  v_mfma_f32_32x32x16_bf16 v[64:79], v[48:51], v[196:199], v[64:79]
  ds_read_b64_tr_b16 v[44:45], v25 offset:0
  ds_read_b64_tr_b16 v[46:47], v25 offset:2048
  s_waitcnt lgkmcnt(13)
  v_mfma_f32_32x32x16_bf16 v[80:95], v[52:55], v[196:199], v[80:95]
  ds_read_b64_tr_b16 v[48:49], v22 offset:4096
  ds_read_b64_tr_b16 v[50:51], v22 offset:6144
  s_waitcnt lgkmcnt(13)
  v_mfma_f32_32x32x16_bf16 v[96:111], v[56:59], v[196:199], v[96:111]
  ds_read_b64_tr_b16 v[52:53], v23 offset:4096
  ds_read_b64_tr_b16 v[54:55], v23 offset:6144
  s_waitcnt lgkmcnt(13)
  v_mfma_f32_32x32x16_bf16 v[112:127], v[60:63], v[196:199], v[112:127]
  ds_read_b64_tr_b16 v[56:57], v24 offset:4096
  ds_read_b64_tr_b16 v[58:59], v24 offset:6144
  s_waitcnt lgkmcnt(12)
  v_mfma_f32_32x32x16_bf16 v[64:79], v[32:35], v[208:211], v[64:79]
  ds_read_b64_tr_b16 v[60:61], v25 offset:4096
  ds_read_b64_tr_b16 v[62:63], v25 offset:6144
  v_mov_b32 v28, 24
  s_mov_b64 exec, 1
  ds_write_b32 v3, v28 offset:16
  s_mov_b64 exec, -1
  s_waitcnt lgkmcnt(13)
  v_mfma_f32_32x32x16_bf16 v[80:95], v[36:39], v[208:211], v[80:95]
  s_cmp_ge_u32 s92, 24
  s_cbranch_scc1 L_OK51
L_SP52:
  ds_read_b128 v[28:31], v2 offset:0
  s_waitcnt lgkmcnt(0)
  v_min3_u32 v28, v28, v29, v30
  v_min_u32 v28, v28, v31
  s_nop 0
  v_readfirstlane_b32 s92, v28
  s_add_i32 s93, s93, -1
  s_cmp_lt_i32 s93, 0
  s_cbranch_scc1 L_OK51
  s_cmp_ge_u32 s92, 24
  s_cbranch_scc0 L_SP52
L_OK51:
  v_add_u32 v22, 0x0, v11
  v_add_u32 v23, 0x0, v12
  v_add_u32 v24, 0x0, v13
  v_add_u32 v25, 0x0, v14
  ds_read_b64_tr_b16 v[32:33], v22 offset:0
  ds_read_b64_tr_b16 v[34:35], v22 offset:2048
  s_waitcnt lgkmcnt(13)
  v_mfma_f32_32x32x16_bf16 v[96:111], v[40:43], v[208:211], v[96:111]
  ds_read_b64_tr_b16 v[36:37], v23 offset:0
  ds_read_b64_tr_b16 v[38:39], v23 offset:2048
  s_waitcnt lgkmcnt(13)
  v_mfma_f32_32x32x16_bf16 v[112:127], v[44:47], v[208:211], v[112:127]
  ds_read_b64_tr_b16 v[40:41], v24 offset:0
  ds_read_b64_tr_b16 v[42:43], v24 offset:2048
  s_waitcnt lgkmcnt(13)
  v_mfma_f32_32x32x16_bf16 v[64:79], v[48:51], v[212:215], v[64:79]
  ds_read_b64_tr_b16 v[44:45], v25 offset:0
  ds_read_b64_tr_b16 v[46:47], v25 offset:2048
  s_waitcnt lgkmcnt(13)
  v_mfma_f32_32x32x16_bf16 v[80:95], v[52:55], v[212:215], v[80:95]
  ds_read_b64_tr_b16 v[48:49], v22 offset:4096
  ds_read_b64_tr_b16 v[50:51], v22 offset:6144
  s_waitcnt lgkmcnt(13)
  v_mfma_f32_32x32x16_bf16 v[96:111], v[56:59], v[212:215], v[96:111]
  ds_read_b64_tr_b16 v[52:53], v23 offset:4096
  ds_read_b64_tr_b16 v[54:55], v23 offset:6144
  s_waitcnt lgkmcnt(13)
  v_mfma_f32_32x32x16_bf16 v[112:127], v[60:63], v[212:215], v[112:127]
  ds_read_b64_tr_b16 v[56:57], v24 offset:4096
  ds_read_b64_tr_b16 v[58:59], v24 offset:6144
  s_waitcnt lgkmcnt(12)
  v_mfma_f32_32x32x16_bf16 v[64:79], v[32:35], v[224:227], v[64:79]
  ds_read_b64_tr_b16 v[60:61], v25 offset:4096
  ds_read_b64_tr_b16 v[62:63], v25 offset:6144
  v_mov_b32 v28, 25
  s_mov_b64 exec, 1
  ds_write_b32 v3, v28 offset:16
  s_mov_b64 exec, -1
  s_waitcnt lgkmcnt(13)
  v_mfma_f32_32x32x16_bf16 v[80:95], v[36:39], v[224:227], v[80:95]
  s_cmp_ge_u32 s92, 25
  s_cbranch_scc1 L_OK53
L_SP54:
  ds_read_b128 v[28:31], v2 offset:0
  s_waitcnt lgkmcnt(0)
  v_min3_u32 v28, v28, v29, v30
  v_min_u32 v28, v28, v31
  s_nop 0
  v_readfirstlane_b32 s92, v28
  s_add_i32 s93, s93, -1
  s_cmp_lt_i32 s93, 0
  s_cbranch_scc1 L_OK53
  s_cmp_ge_u32 s92, 25
  s_cbranch_scc0 L_SP54
L_OK53:
  v_add_u32 v22, 0x8000, v11
  v_add_u32 v23, 0x8000, v12
  v_add_u32 v24, 0x8000, v13
  v_add_u32 v25, 0x8000, v14
  ds_read_b64_tr_b16 v[32:33], v22 offset:0
  ds_read_b64_tr_b16 v[34:35], v22 offset:2048
  s_waitcnt lgkmcnt(13)
  v_mfma_f32_32x32x16_bf16 v[96:111], v[40:43], v[224:227], v[96:111]
  ds_read_b64_tr_b16 v[36:37], v23 offset:0
  ds_read_b64_tr_b16 v[38:39], v23 offset:2048
  s_waitcnt lgkmcnt(13)
  v_mfma_f32_32x32x16_bf16 v[112:127], v[44:47], v[224:227], v[112:127]
  ds_read_b64_tr_b16 v[40:41], v24 offset:0
  ds_read_b64_tr_b16 v[42:43], v24 offset:2048
  s_waitcnt lgkmcnt(13)
  v_mfma_f32_32x32x16_bf16 v[64:79], v[48:51], v[228:231], v[64:79]
  ds_read_b64_tr_b16 v[44:45], v25 offset:0
  ds_read_b64_tr_b16 v[46:47], v25 offset:2048
  s_waitcnt lgkmcnt(13)
  v_mfma_f32_32x32x16_bf16 v[80:95], v[52:55], v[228:231], v[80:95]
  ds_read_b64_tr_b16 v[48:49], v22 offset:4096
  ds_read_b64_tr_b16 v[50:51], v22 offset:6144
  s_waitcnt lgkmcnt(13)
  v_mfma_f32_32x32x16_bf16 v[96:111], v[56:59], v[228:231], v[96:111]
  ds_read_b64_tr_b16 v[52:53], v23 offset:4096
  ds_read_b64_tr_b16 v[54:55], v23 offset:6144
  s_waitcnt lgkmcnt(13)
  v_mfma_f32_32x32x16_bf16 v[112:127], v[60:63], v[228:231], v[112:127]
  ds_read_b64_tr_b16 v[56:57], v24 offset:4096
  ds_read_b64_tr_b16 v[58:59], v24 offset:6144
  s_waitcnt lgkmcnt(12)
  v_mfma_f32_32x32x16_bf16 v[64:79], v[32:35], v[240:243], v[64:79]
  ds_read_b64_tr_b16 v[60:61], v25 offset:4096
  ds_read_b64_tr_b16 v[62:63], v25 offset:6144
  v_mov_b32 v28, 26
  s_mov_b64 exec, 1
  ds_write_b32 v3, v28 offset:16
  s_mov_b64 exec, -1
  s_waitcnt lgkmcnt(13)
  v_mfma_f32_32x32x16_bf16 v[80:95], v[36:39], v[240:243], v[80:95]
  s_waitcnt lgkmcnt(11)
  v_mfma_f32_32x32x16_bf16 v[96:111], v[40:43], v[240:243], v[96:111]
  s_waitcnt lgkmcnt(9)
  v_mfma_f32_32x32x16_bf16 v[112:127], v[44:47], v[240:243], v[112:127]
  s_waitcnt lgkmcnt(7)
  v_mfma_f32_32x32x16_bf16 v[64:79], v[48:51], v[244:247], v[64:79]
  s_waitcnt lgkmcnt(5)
  v_mfma_f32_32x32x16_bf16 v[80:95], v[52:55], v[244:247], v[80:95]
  s_waitcnt lgkmcnt(3)
  v_mfma_f32_32x32x16_bf16 v[96:111], v[56:59], v[244:247], v[96:111]
  s_waitcnt lgkmcnt(1)
  v_mfma_f32_32x32x16_bf16 v[112:127], v[60:63], v[244:247], v[112:127]
  s_lshl_b32 s60, s56, 13
  s_add_u32 s60, s60, 81920
  v_add_u32 v20, s60, v27
  v_xor_b32 v24, 0x2000, v20
  v_add_u32 v22, 0x1c000, v26
  s_cmp_ge_u32 s94, 24
  s_cbranch_scc1 L_OK55
L_SP56:
  ds_read_b128 v[28:31], v2 offset:16
  s_waitcnt lgkmcnt(0)
  v_min3_u32 v28, v28, v29, v30
  v_min_u32 v28, v28, v31
  s_nop 0
  v_readfirstlane_b32 s94, v28
  s_add_i32 s93, s93, -1
  s_cmp_lt_i32 s93, 0
  s_cbranch_scc1 L_OK55
  s_cmp_ge_u32 s94, 24
  s_cbranch_scc0 L_SP56
L_OK55:
  s_nop 7
  ds_write_b128 v20, v[96:99] offset:0
  ds_write_b128 v20, v[100:103] offset:1024
  ds_write_b128 v20, v[104:107] offset:2048
  ds_write_b128 v20, v[108:111] offset:3072
  ds_write_b128 v20, v[112:115] offset:4096
  ds_write_b128 v20, v[116:119] offset:5120
  ds_write_b128 v20, v[120:123] offset:6144
  ds_write_b128 v20, v[124:127] offset:7168
  v_mov_b32 v28, 1
  s_mov_b64 exec, 1
  ds_write_b32 v3, v28 offset:64
  s_mov_b64 exec, -1
  s_mov_b32 s63, 0
  s_cmp_ge_u32 s63, 1
  s_cbranch_scc1 L_OK57
L_SP58:
  ds_read_b32 v28, v0 offset:64
  s_waitcnt lgkmcnt(0)
  v_readfirstlane_b32 s63, v28
  s_add_i32 s93, s93, -1
  s_cmp_lt_i32 s93, 0
  s_cbranch_scc1 L_OK57
  s_cmp_ge_u32 s63, 1
  s_cbranch_scc0 L_SP58
L_OK57:
  ds_read_b32 v6, v21 offset:0
  ds_read_b32 v7, v21 offset:1024
  ds_read_b128 v[32:35], v24 offset:0
  ds_read_b128 v[36:39], v24 offset:1024
  ds_read_b128 v[40:43], v24 offset:2048
  ds_read_b128 v[44:47], v24 offset:3072
  ds_read_b128 v[48:51], v24 offset:4096
  ds_read_b128 v[52:55], v24 offset:5120
  ds_read_b128 v[56:59], v24 offset:6144
  ds_read_b128 v[60:63], v24 offset:7168
  v_mov_b32 v28, 27
  s_mov_b64 exec, 1
  ds_write_b32 v3, v28 offset:16
  s_mov_b64 exec, -1
  s_waitcnt lgkmcnt(9)
  v_max_f32 v23, v6, v4
  v_sub_f32 v4, v4, v23
  v_sub_f32 v6, v6, v23
  v_mul_f32 v4, s64, v4
  v_mul_f32 v6, s64, v6
  v_exp_f32 v4, v4
  v_exp_f32 v6, v6
  s_nop 0
  v_mul_f32 v5, v5, v4
  v_fma_f32 v5, v7, v6, v5
  v_rcp_f32 v5, v5
  s_nop 0
  v_mul_f32 v8, v6, v5
  v_mul_f32 v6, v4, v5
  v_mov_b32 v9, v8
  v_mov_b32 v7, v6
  s_waitcnt lgkmcnt(8)
  v_pk_mul_f32 v[64:65], v[64:65], v[6:7]
  v_pk_fma_f32 v[64:65], v[32:33], v[8:9], v[64:65]
  v_pk_mul_f32 v[66:67], v[66:67], v[6:7]
  v_pk_fma_f32 v[66:67], v[34:35], v[8:9], v[66:67]
  v_cvt_pk_bf16_f32 v96, v64, v65
  v_cvt_pk_bf16_f32 v97, v66, v67
  s_waitcnt lgkmcnt(7)
  v_pk_mul_f32 v[68:69], v[68:69], v[6:7]
  v_pk_fma_f32 v[68:69], v[36:37], v[8:9], v[68:69]
  v_pk_mul_f32 v[70:71], v[70:71], v[6:7]
  v_pk_fma_f32 v[70:71], v[38:39], v[8:9], v[70:71]
  v_cvt_pk_bf16_f32 v98, v68, v69
  v_cvt_pk_bf16_f32 v99, v70, v71
  buffer_store_dwordx4 v[96:99], v26, s[28:31], s68 offen offset:0 sc1
  ds_write_b128 v22, v[96:99] offset:0
  s_waitcnt lgkmcnt(7)
  v_pk_mul_f32 v[72:73], v[72:73], v[6:7]
  v_pk_fma_f32 v[72:73], v[40:41], v[8:9], v[72:73]
  v_pk_mul_f32 v[74:75], v[74:75], v[6:7]
  v_pk_fma_f32 v[74:75], v[42:43], v[8:9], v[74:75]
  v_cvt_pk_bf16_f32 v100, v72, v73
  v_cvt_pk_bf16_f32 v101, v74, v75
  s_waitcnt lgkmcnt(6)
  v_pk_mul_f32 v[76:77], v[76:77], v[6:7]
  v_pk_fma_f32 v[76:77], v[44:45], v[8:9], v[76:77]
  v_pk_mul_f32 v[78:79], v[78:79], v[6:7]
  v_pk_fma_f32 v[78:79], v[46:47], v[8:9], v[78:79]
  v_cvt_pk_bf16_f32 v102, v76, v77
  v_cvt_pk_bf16_f32 v103, v78, v79
  buffer_store_dwordx4 v[100:103], v26, s[28:31], s68 offen offset:1024 sc1
  ds_write_b128 v22, v[100:103] offset:1024
  s_waitcnt lgkmcnt(6)
  v_pk_mul_f32 v[80:81], v[80:81], v[6:7]
  v_pk_fma_f32 v[80:81], v[48:49], v[8:9], v[80:81]
  v_pk_mul_f32 v[82:83], v[82:83], v[6:7]
  v_pk_fma_f32 v[82:83], v[50:51], v[8:9], v[82:83]
  v_cvt_pk_bf16_f32 v104, v80, v81
  v_cvt_pk_bf16_f32 v105, v82, v83
  s_waitcnt lgkmcnt(5)
  v_pk_mul_f32 v[84:85], v[84:85], v[6:7]
  v_pk_fma_f32 v[84:85], v[52:53], v[8:9], v[84:85]
  v_pk_mul_f32 v[86:87], v[86:87], v[6:7]
  v_pk_fma_f32 v[86:87], v[54:55], v[8:9], v[86:87]
  v_cvt_pk_bf16_f32 v106, v84, v85
  v_cvt_pk_bf16_f32 v107, v86, v87
  buffer_store_dwordx4 v[104:107], v26, s[28:31], s68 offen offset:2048 sc1
  ds_write_b128 v22, v[104:107] offset:2048
  s_waitcnt lgkmcnt(5)
  v_pk_mul_f32 v[88:89], v[88:89], v[6:7]
  v_pk_fma_f32 v[88:89], v[56:57], v[8:9], v[88:89]
  v_pk_mul_f32 v[90:91], v[90:91], v[6:7]
  v_pk_fma_f32 v[90:91], v[58:59], v[8:9], v[90:91]
  v_cvt_pk_bf16_f32 v108, v88, v89
  v_cvt_pk_bf16_f32 v109, v90, v91
  s_waitcnt lgkmcnt(4)
  v_pk_mul_f32 v[92:93], v[92:93], v[6:7]
  v_pk_fma_f32 v[92:93], v[60:61], v[8:9], v[92:93]
  v_pk_mul_f32 v[94:95], v[94:95], v[6:7]
  v_pk_fma_f32 v[94:95], v[62:63], v[8:9], v[94:95]
  v_cvt_pk_bf16_f32 v110, v92, v93
  v_cvt_pk_bf16_f32 v111, v94, v95
  buffer_store_dwordx4 v[108:111], v26, s[28:31], s68 offen offset:3072 sc1
  ds_write_b128 v22, v[108:111] offset:3072
  v_mov_b32 v28, 1
  s_mov_b64 exec, 1
  ds_write_b32 v3, v28 offset:80
  s_mov_b64 exec, -1
  v_xor_b32 v20, s58, v96
  v_xor_b32 v20, v97, v20
  v_xor_b32 v20, v98, v20
  v_xor_b32 v20, v99, v20
  v_xor_b32 v20, v100, v20
  v_xor_b32 v20, v101, v20
  v_xor_b32 v20, v102, v20
  v_xor_b32 v20, v103, v20
  v_xor_b32 v20, v104, v20
  v_xor_b32 v20, v105, v20
  v_xor_b32 v20, v106, v20
  v_xor_b32 v20, v107, v20
  v_xor_b32 v20, v108, v20
  v_xor_b32 v20, v109, v20
  v_xor_b32 v20, v110, v20
  v_xor_b32 v20, v111, v20
  s_lshl_b32 s60, s59, 2
  s_add_u32 s60, s60, s56
  s_lshl_b32 s60, s60, 8
  s_add_u32 s60, s60, 0x10000
  v_lshrrev_b32 v21, 2, v27
  buffer_store_dword v20, v21, s[28:31], s60 offen sc1
  s_mov_b32 s63, 0
  s_cmp_ge_u32 s63, 1
  s_cbranch_scc1 L_OK59
L_SP60:
  ds_read_b128 v[28:31], v2 offset:80
  s_waitcnt lgkmcnt(0)
  v_min3_u32 v28, v28, v29, v30
  v_min_u32 v28, v28, v31
  s_nop 0
  v_readfirstlane_b32 s63, v28
  s_add_i32 s93, s93, -1
  s_cmp_lt_i32 s93, 0
  s_cbranch_scc1 L_OK59
  s_cmp_ge_u32 s63, 1
  s_cbranch_scc0 L_SP60
L_OK59:
  s_cmp_ge_u32 s92, 28
  s_cbranch_scc1 L_OK61
L_SP62:
  ds_read_b128 v[28:31], v2 offset:0
  s_waitcnt lgkmcnt(0)
  v_min3_u32 v28, v28, v29, v30
  v_min_u32 v28, v28, v31
  s_nop 0
  v_readfirstlane_b32 s92, v28
  s_add_i32 s93, s93, -1
  s_cmp_lt_i32 s93, 0
  s_cbranch_scc1 L_OK61
  s_cmp_ge_u32 s92, 28
  s_cbranch_scc0 L_SP62
L_OK61:
  v_add_u32 v22, 0x4000, v15
  v_add_u32 v24, 0x1c000, v27
  v_add_u32 v25, 0x1c000, v19
  ds_read_b64_tr_b16 v[32:33], v22 offset:0
  ds_read_b64_tr_b16 v[34:35], v22 offset:2048
  ds_read_b128 v[96:99], v24 offset:0
  ds_read_b128 v[100:103], v24 offset:8192
  ds_read_b64_tr_b16 v[196:197], v18 offset:0
  ds_read_b64_tr_b16 v[198:199], v18 offset:256
  ds_read_b128 v[204:207], v25 offset:0
  ds_read_b64_tr_b16 v[36:37], v22 offset:4096
  ds_read_b64_tr_b16 v[38:39], v22 offset:6144
  ds_read_b128 v[104:107], v24 offset:1024
  ds_read_b128 v[108:111], v24 offset:9216
  s_waitcnt lgkmcnt(8)
  v_mfma_f32_32x32x16_bf16 v[160:175], v[32:35], v[96:99], 0
  ds_read_b64_tr_b16 v[40:41], v22 offset:8192
  ds_read_b64_tr_b16 v[42:43], v22 offset:10240
  ds_read_b128 v[112:115], v24 offset:2048
  s_waitcnt lgkmcnt(10)
  v_mfma_f32_32x32x16_bf16 v[176:191], v[32:35], v[100:103], 0
  s_waitcnt lgkmcnt(7)
  v_mfma_f32_16x16x32_bf16 v[192:195], v[196:199], v[204:207], 0
  ds_read_b128 v[116:119], v24 offset:10240
  ds_read_b64_tr_b16 v[200:201], v18 offset:1024
  ds_read_b64_tr_b16 v[202:203], v18 offset:1280
  ds_read_b128 v[208:211], v25 offset:2048
  s_waitcnt lgkmcnt(8)
  v_mfma_f32_32x32x16_bf16 v[160:175], v[36:39], v[104:107], v[160:175]
  ds_read_b64_tr_b16 v[44:45], v22 offset:12288
  ds_read_b64_tr_b16 v[46:47], v22 offset:14336
  ds_read_b128 v[120:123], v24 offset:3072
  s_waitcnt lgkmcnt(10)
  v_mfma_f32_32x32x16_bf16 v[176:191], v[36:39], v[108:111], v[176:191]
  ds_read_b128 v[124:127], v24 offset:11264
  v_mov_b32 v28, 28
  s_mov_b64 exec, 1
  ds_write_b32 v3, v28 offset:16
  s_mov_b64 exec, -1
  s_waitcnt lgkmcnt(9)
  v_mfma_f32_32x32x16_bf16 v[160:175], v[40:43], v[112:115], v[160:175]
  s_cmp_ge_u32 s92, 29
  s_cbranch_scc1 L_OK63
L_SP64:
  ds_read_b128 v[28:31], v2 offset:0
  s_waitcnt lgkmcnt(0)
  v_min3_u32 v28, v28, v29, v30
  v_min_u32 v28, v28, v31
  s_nop 0
  v_readfirstlane_b32 s92, v28
  s_add_i32 s93, s93, -1
  s_cmp_lt_i32 s93, 0
  s_cbranch_scc1 L_OK63
  s_cmp_ge_u32 s92, 29
  s_cbranch_scc0 L_SP64
L_OK63:
  v_add_u32 v22, 0xc000, v15
  ds_read_b64_tr_b16 v[32:33], v22 offset:0
  ds_read_b64_tr_b16 v[34:35], v22 offset:2048
  ds_read_b128 v[96:99], v24 offset:4096
  s_waitcnt lgkmcnt(11)
  v_mfma_f32_32x32x16_bf16 v[176:191], v[40:43], v[116:119], v[176:191]
  s_waitcnt lgkmcnt(8)
  v_mfma_f32_16x16x32_bf16 v[192:195], v[200:203], v[208:211], v[192:195]
  ds_read_b128 v[100:103], v24 offset:12288
  ds_read_b64_tr_b16 v[196:197], v18 offset:2048
  ds_read_b64_tr_b16 v[198:199], v18 offset:2304
  ds_read_b128 v[204:207], v25 offset:4096
  s_waitcnt lgkmcnt(9)
  v_mfma_f32_32x32x16_bf16 v[160:175], v[44:47], v[120:123], v[160:175]
  ds_read_b64_tr_b16 v[36:37], v22 offset:4096
  ds_read_b64_tr_b16 v[38:39], v22 offset:6144
  ds_read_b128 v[104:107], v24 offset:5120
  s_waitcnt lgkmcnt(11)
  v_mfma_f32_32x32x16_bf16 v[176:191], v[44:47], v[124:127], v[176:191]
  ds_read_b128 v[108:111], v24 offset:13312
  s_waitcnt lgkmcnt(8)
  v_mfma_f32_32x32x16_bf16 v[160:175], v[32:35], v[96:99], v[160:175]
  ds_read_b64_tr_b16 v[40:41], v22 offset:8192
  ds_read_b64_tr_b16 v[42:43], v22 offset:10240
  ds_read_b128 v[112:115], v24 offset:6144
  s_waitcnt lgkmcnt(10)
  v_mfma_f32_32x32x16_bf16 v[176:191], v[32:35], v[100:103], v[176:191]
  s_waitcnt lgkmcnt(7)
  v_mfma_f32_16x16x32_bf16 v[192:195], v[196:199], v[204:207], v[192:195]
  ds_read_b128 v[116:119], v24 offset:14336
  ds_read_b64_tr_b16 v[200:201], v18 offset:3072
  ds_read_b64_tr_b16 v[202:203], v18 offset:3328
  ds_read_b128 v[208:211], v25 offset:6144
  s_waitcnt lgkmcnt(8)
  v_mfma_f32_32x32x16_bf16 v[160:175], v[36:39], v[104:107], v[160:175]
  ds_read_b64_tr_b16 v[44:45], v22 offset:12288
  ds_read_b64_tr_b16 v[46:47], v22 offset:14336
  ds_read_b128 v[120:123], v24 offset:7168
  s_waitcnt lgkmcnt(10)
  v_mfma_f32_32x32x16_bf16 v[176:191], v[36:39], v[108:111], v[176:191]
  ds_read_b128 v[124:127], v24 offset:15360
  v_mov_b32 v28, 29
  s_mov_b64 exec, 1
  ds_write_b32 v3, v28 offset:16
  s_mov_b64 exec, -1
  s_waitcnt lgkmcnt(9)
  v_mfma_f32_32x32x16_bf16 v[160:175], v[40:43], v[112:115], v[160:175]
  s_cmp_ge_u32 s92, 30
  s_cbranch_scc1 L_OK65
L_SP66:
  ds_read_b128 v[28:31], v2 offset:0
  s_waitcnt lgkmcnt(0)
  v_min3_u32 v28, v28, v29, v30
  v_min_u32 v28, v28, v31
  s_nop 0
  v_readfirstlane_b32 s92, v28
  s_add_i32 s93, s93, -1
  s_cmp_lt_i32 s93, 0
  s_cbranch_scc1 L_OK65
  s_cmp_ge_u32 s92, 30
  s_cbranch_scc0 L_SP66
L_OK65:
  s_cmp_ge_u32 s92, 34
  s_cbranch_scc1 L_OK67
L_SP68:
  ds_read_b128 v[28:31], v2 offset:0
  s_waitcnt lgkmcnt(0)
  v_min3_u32 v28, v28, v29, v30
  v_min_u32 v28, v28, v31
  s_nop 0
  v_readfirstlane_b32 s92, v28
  s_add_i32 s93, s93, -1
  s_cmp_lt_i32 s93, 0
  s_cbranch_scc1 L_OK67
  s_cmp_ge_u32 s92, 34
  s_cbranch_scc0 L_SP68
L_OK67:
  v_add_u32 v22, 0x10000, v15
  v_add_u32 v24, 0x8000, v27
  v_add_u32 v25, 0x8000, v19
  ds_read_b64_tr_b16 v[32:33], v22 offset:0
  ds_read_b64_tr_b16 v[34:35], v22 offset:2048
  ds_read_b128 v[96:99], v24 offset:0
  s_waitcnt lgkmcnt(11)
  v_mfma_f32_32x32x16_bf16 v[176:191], v[40:43], v[116:119], v[176:191]
  s_waitcnt lgkmcnt(8)
  v_mfma_f32_16x16x32_bf16 v[192:195], v[200:203], v[208:211], v[192:195]
  ds_read_b128 v[100:103], v24 offset:8192
  ds_read_b64_tr_b16 v[196:197], v18 offset:4096
  ds_read_b64_tr_b16 v[198:199], v18 offset:4352
  ds_read_b128 v[204:207], v25 offset:0
  s_waitcnt lgkmcnt(9)
  v_mfma_f32_32x32x16_bf16 v[160:175], v[44:47], v[120:123], v[160:175]
  ds_read_b64_tr_b16 v[36:37], v22 offset:4096
  ds_read_b64_tr_b16 v[38:39], v22 offset:6144
  ds_read_b128 v[104:107], v24 offset:1024
  s_waitcnt lgkmcnt(11)
  v_mfma_f32_32x32x16_bf16 v[176:191], v[44:47], v[124:127], v[176:191]
  ds_read_b128 v[108:111], v24 offset:9216
  s_waitcnt lgkmcnt(8)
  v_mfma_f32_32x32x16_bf16 v[160:175], v[32:35], v[96:99], v[160:175]
  ds_read_b64_tr_b16 v[40:41], v22 offset:8192
  ds_read_b64_tr_b16 v[42:43], v22 offset:10240
  ds_read_b128 v[112:115], v24 offset:2048
  s_waitcnt lgkmcnt(10)
  v_mfma_f32_32x32x16_bf16 v[176:191], v[32:35], v[100:103], v[176:191]
  s_waitcnt lgkmcnt(7)
  v_mfma_f32_16x16x32_bf16 v[192:195], v[196:199], v[204:207], v[192:195]
  ds_read_b128 v[116:119], v24 offset:10240
  ds_read_b64_tr_b16 v[200:201], v18 offset:5120
  ds_read_b64_tr_b16 v[202:203], v18 offset:5376
  ds_read_b128 v[208:211], v25 offset:2048
  s_waitcnt lgkmcnt(8)
  v_mfma_f32_32x32x16_bf16 v[160:175], v[36:39], v[104:107], v[160:175]
  ds_read_b64_tr_b16 v[44:45], v22 offset:12288
  ds_read_b64_tr_b16 v[46:47], v22 offset:14336
  ds_read_b128 v[120:123], v24 offset:3072
  s_waitcnt lgkmcnt(10)
  v_mfma_f32_32x32x16_bf16 v[176:191], v[36:39], v[108:111], v[176:191]
  ds_read_b128 v[124:127], v24 offset:11264
  v_mov_b32 v28, 30
  s_mov_b64 exec, 1
  ds_write_b32 v3, v28 offset:16
  s_mov_b64 exec, -1
  s_waitcnt lgkmcnt(9)
  v_mfma_f32_32x32x16_bf16 v[160:175], v[40:43], v[112:115], v[160:175]
  s_cmp_ge_u32 s92, 31
  s_cbranch_scc1 L_OK69
L_SP70:
  ds_read_b128 v[28:31], v2 offset:0
  s_waitcnt lgkmcnt(0)
  v_min3_u32 v28, v28, v29, v30
  v_min_u32 v28, v28, v31
  s_nop 0
  v_readfirstlane_b32 s92, v28
  s_add_i32 s93, s93, -1
  s_cmp_lt_i32 s93, 0
  s_cbranch_scc1 L_OK69
  s_cmp_ge_u32 s92, 31
  s_cbranch_scc0 L_SP70
L_OK69:
  v_add_u32 v22, 0x0, v15
  ds_read_b64_tr_b16 v[32:33], v22 offset:0
  ds_read_b64_tr_b16 v[34:35], v22 offset:2048
  ds_read_b128 v[96:99], v24 offset:4096
  s_waitcnt lgkmcnt(11)
  v_mfma_f32_32x32x16_bf16 v[176:191], v[40:43], v[116:119], v[176:191]
  s_waitcnt lgkmcnt(8)
  v_mfma_f32_16x16x32_bf16 v[192:195], v[200:203], v[208:211], v[192:195]
  ds_read_b128 v[100:103], v24 offset:12288
  ds_read_b64_tr_b16 v[196:197], v18 offset:6144
  ds_read_b64_tr_b16 v[198:199], v18 offset:6400
  ds_read_b128 v[204:207], v25 offset:4096
  s_waitcnt lgkmcnt(9)
  v_mfma_f32_32x32x16_bf16 v[160:175], v[44:47], v[120:123], v[160:175]
  ds_read_b64_tr_b16 v[36:37], v22 offset:4096
  ds_read_b64_tr_b16 v[38:39], v22 offset:6144
  ds_read_b128 v[104:107], v24 offset:5120
  s_waitcnt lgkmcnt(11)
  v_mfma_f32_32x32x16_bf16 v[176:191], v[44:47], v[124:127], v[176:191]
  ds_read_b128 v[108:111], v24 offset:13312
  s_waitcnt lgkmcnt(8)
  v_mfma_f32_32x32x16_bf16 v[160:175], v[32:35], v[96:99], v[160:175]
  ds_read_b64_tr_b16 v[40:41], v22 offset:8192
  ds_read_b64_tr_b16 v[42:43], v22 offset:10240
  ds_read_b128 v[112:115], v24 offset:6144
  s_waitcnt lgkmcnt(10)
  v_mfma_f32_32x32x16_bf16 v[176:191], v[32:35], v[100:103], v[176:191]
  s_waitcnt lgkmcnt(7)
  v_mfma_f32_16x16x32_bf16 v[192:195], v[196:199], v[204:207], v[192:195]
  ds_read_b128 v[116:119], v24 offset:14336
  ds_read_b64_tr_b16 v[200:201], v18 offset:7168
  ds_read_b64_tr_b16 v[202:203], v18 offset:7424
  ds_read_b128 v[208:211], v25 offset:6144
  s_waitcnt lgkmcnt(8)
  v_mfma_f32_32x32x16_bf16 v[160:175], v[36:39], v[104:107], v[160:175]
  ds_read_b64_tr_b16 v[44:45], v22 offset:12288
  ds_read_b64_tr_b16 v[46:47], v22 offset:14336
  ds_read_b128 v[120:123], v24 offset:7168
  s_waitcnt lgkmcnt(10)
  v_mfma_f32_32x32x16_bf16 v[176:191], v[36:39], v[108:111], v[176:191]
  ds_read_b128 v[124:127], v24 offset:15360
  s_waitcnt lgkmcnt(8)
  v_mfma_f32_32x32x16_bf16 v[160:175], v[40:43], v[112:115], v[160:175]
  s_cmp_ge_u32 s92, 32
  s_cbranch_scc1 L_OK71
L_SP72:
  ds_read_b128 v[28:31], v2 offset:0
  s_waitcnt lgkmcnt(0)
  v_min3_u32 v28, v28, v29, v30
  v_min_u32 v28, v28, v31
  s_nop 0
  v_readfirstlane_b32 s92, v28
  s_add_i32 s93, s93, -1
  s_cmp_lt_i32 s93, 0
  s_cbranch_scc1 L_OK71
  s_cmp_ge_u32 s92, 32
  s_cbranch_scc0 L_SP72
L_OK71:
  s_cmp_ge_u32 s92, 35
  s_cbranch_scc1 L_OK73
L_SP74:
  ds_read_b128 v[28:31], v2 offset:0
  s_waitcnt lgkmcnt(0)
  v_min3_u32 v28, v28, v29, v30
  v_min_u32 v28, v28, v31
  s_nop 0
  v_readfirstlane_b32 s92, v28
  s_add_i32 s93, s93, -1
  s_cmp_lt_i32 s93, 0
  s_cbranch_scc1 L_OK73
  s_cmp_ge_u32 s92, 35
  s_cbranch_scc0 L_SP74
L_OK73:
  v_add_u32 v22, 0x4000, v15
  v_add_u32 v24, 0x14000, v27
  v_add_u32 v25, 0x14000, v19
  ds_read_b64_tr_b16 v[32:33], v22 offset:0
  ds_read_b64_tr_b16 v[34:35], v22 offset:2048
  ds_read_b128 v[96:99], v24 offset:0
  s_waitcnt lgkmcnt(10)
  v_mfma_f32_32x32x16_bf16 v[176:191], v[40:43], v[116:119], v[176:191]
  s_waitcnt lgkmcnt(7)
  v_mfma_f32_16x16x32_bf16 v[192:195], v[200:203], v[208:211], v[192:195]
  ds_read_b128 v[100:103], v24 offset:8192
  ds_read_b64_tr_b16 v[196:197], v18 offset:8192
  ds_read_b64_tr_b16 v[198:199], v18 offset:8448
  ds_read_b128 v[204:207], v25 offset:0
  s_waitcnt lgkmcnt(8)
  v_mfma_f32_32x32x16_bf16 v[160:175], v[44:47], v[120:123], v[160:175]
  ds_read_b64_tr_b16 v[36:37], v22 offset:4096
  ds_read_b64_tr_b16 v[38:39], v22 offset:6144
  ds_read_b128 v[104:107], v24 offset:1024
  s_waitcnt lgkmcnt(10)
  v_mfma_f32_32x32x16_bf16 v[176:191], v[44:47], v[124:127], v[176:191]
  ds_read_b128 v[108:111], v24 offset:9216
  s_waitcnt lgkmcnt(8)
  v_mfma_f32_32x32x16_bf16 v[160:175], v[32:35], v[96:99], v[160:175]
  ds_read_b64_tr_b16 v[40:41], v22 offset:8192
  ds_read_b64_tr_b16 v[42:43], v22 offset:10240
  ds_read_b128 v[112:115], v24 offset:2048
  s_waitcnt lgkmcnt(10)
  v_mfma_f32_32x32x16_bf16 v[176:191], v[32:35], v[100:103], v[176:191]
  s_waitcnt lgkmcnt(7)
  v_mfma_f32_16x16x32_bf16 v[192:195], v[196:199], v[204:207], v[192:195]
  ds_read_b128 v[116:119], v24 offset:10240
  ds_read_b64_tr_b16 v[200:201], v18 offset:9216
  ds_read_b64_tr_b16 v[202:203], v18 offset:9472
  ds_read_b128 v[208:211], v25 offset:2048
  s_waitcnt lgkmcnt(8)
  v_mfma_f32_32x32x16_bf16 v[160:175], v[36:39], v[104:107], v[160:175]
  ds_read_b64_tr_b16 v[44:45], v22 offset:12288
  ds_read_b64_tr_b16 v[46:47], v22 offset:14336
  ds_read_b128 v[120:123], v24 offset:3072
  s_waitcnt lgkmcnt(10)
  v_mfma_f32_32x32x16_bf16 v[176:191], v[36:39], v[108:111], v[176:191]
  ds_read_b128 v[124:127], v24 offset:11264
  s_waitcnt lgkmcnt(8)
  v_mfma_f32_32x32x16_bf16 v[160:175], v[40:43], v[112:115], v[160:175]
  s_cmp_ge_u32 s92, 33
  s_cbranch_scc1 L_OK75
L_SP76:
  ds_read_b128 v[28:31], v2 offset:0
  s_waitcnt lgkmcnt(0)
  v_min3_u32 v28, v28, v29, v30
  v_min_u32 v28, v28, v31
  s_nop 0
  v_readfirstlane_b32 s92, v28
  s_add_i32 s93, s93, -1
  s_cmp_lt_i32 s93, 0
  s_cbranch_scc1 L_OK75
  s_cmp_ge_u32 s92, 33
  s_cbranch_scc0 L_SP76
L_OK75:
  v_add_u32 v22, 0xc000, v15
  ds_read_b64_tr_b16 v[32:33], v22 offset:0
  ds_read_b64_tr_b16 v[34:35], v22 offset:2048
  ds_read_b128 v[96:99], v24 offset:4096
  s_waitcnt lgkmcnt(10)
  v_mfma_f32_32x32x16_bf16 v[176:191], v[40:43], v[116:119], v[176:191]
  s_waitcnt lgkmcnt(7)
  v_mfma_f32_16x16x32_bf16 v[192:195], v[200:203], v[208:211], v[192:195]
  ds_read_b128 v[100:103], v24 offset:12288
  ds_read_b64_tr_b16 v[196:197], v18 offset:10240
  ds_read_b64_tr_b16 v[198:199], v18 offset:10496
  ds_read_b128 v[204:207], v25 offset:4096
  s_waitcnt lgkmcnt(8)
  v_mfma_f32_32x32x16_bf16 v[160:175], v[44:47], v[120:123], v[160:175]
  ds_read_b64_tr_b16 v[36:37], v22 offset:4096
  ds_read_b64_tr_b16 v[38:39], v22 offset:6144
  ds_read_b128 v[104:107], v24 offset:5120
  s_waitcnt lgkmcnt(10)
  v_mfma_f32_32x32x16_bf16 v[176:191], v[44:47], v[124:127], v[176:191]
  ds_read_b128 v[108:111], v24 offset:13312
  s_waitcnt lgkmcnt(8)
  v_mfma_f32_32x32x16_bf16 v[160:175], v[32:35], v[96:99], v[160:175]
  ds_read_b64_tr_b16 v[40:41], v22 offset:8192
  ds_read_b64_tr_b16 v[42:43], v22 offset:10240
  ds_read_b128 v[112:115], v24 offset:6144
  s_waitcnt lgkmcnt(10)
  v_mfma_f32_32x32x16_bf16 v[176:191], v[32:35], v[100:103], v[176:191]
  s_waitcnt lgkmcnt(7)
  v_mfma_f32_16x16x32_bf16 v[192:195], v[196:199], v[204:207], v[192:195]
  ds_read_b128 v[116:119], v24 offset:14336
  ds_read_b64_tr_b16 v[200:201], v18 offset:11264
  ds_read_b64_tr_b16 v[202:203], v18 offset:11520
  ds_read_b128 v[208:211], v25 offset:6144
  s_waitcnt lgkmcnt(8)
  v_mfma_f32_32x32x16_bf16 v[160:175], v[36:39], v[104:107], v[160:175]
  ds_read_b64_tr_b16 v[44:45], v22 offset:12288
  ds_read_b64_tr_b16 v[46:47], v22 offset:14336
  ds_read_b128 v[120:123], v24 offset:7168
  s_waitcnt lgkmcnt(10)
  v_mfma_f32_32x32x16_bf16 v[176:191], v[36:39], v[108:111], v[176:191]
  ds_read_b128 v[124:127], v24 offset:15360
  s_waitcnt lgkmcnt(8)
  v_mfma_f32_32x32x16_bf16 v[160:175], v[40:43], v[112:115], v[160:175]
  s_cmp_ge_u32 s92, 37
  s_cbranch_scc1 L_OK77
L_SP78:
  ds_read_b128 v[28:31], v2 offset:0
  s_waitcnt lgkmcnt(0)
  v_min3_u32 v28, v28, v29, v30
  v_min_u32 v28, v28, v31
  s_nop 0
  v_readfirstlane_b32 s92, v28
  s_add_i32 s93, s93, -1
  s_cmp_lt_i32 s93, 0
  s_cbranch_scc1 L_OK77
  s_cmp_ge_u32 s92, 37
  s_cbranch_scc0 L_SP78
L_OK77:
  s_cmp_ge_u32 s92, 36
  s_cbranch_scc1 L_OK79
L_SP80:
  ds_read_b128 v[28:31], v2 offset:0
  s_waitcnt lgkmcnt(0)
  v_min3_u32 v28, v28, v29, v30
  v_min_u32 v28, v28, v31
  s_nop 0
  v_readfirstlane_b32 s92, v28
  s_add_i32 s93, s93, -1
  s_cmp_lt_i32 s93, 0
  s_cbranch_scc1 L_OK79
  s_cmp_ge_u32 s92, 36
  s_cbranch_scc0 L_SP80
L_OK79:
  v_add_u32 v22, 0x1c000, v15
  v_add_u32 v24, 0x18000, v27
  v_add_u32 v25, 0x18000, v19
  ds_read_b64_tr_b16 v[32:33], v22 offset:0
  ds_read_b64_tr_b16 v[34:35], v22 offset:2048
  ds_read_b128 v[96:99], v24 offset:0
  s_waitcnt lgkmcnt(10)
  v_mfma_f32_32x32x16_bf16 v[176:191], v[40:43], v[116:119], v[176:191]
  s_waitcnt lgkmcnt(7)
  v_mfma_f32_16x16x32_bf16 v[192:195], v[200:203], v[208:211], v[192:195]
  ds_read_b128 v[100:103], v24 offset:8192
  ds_read_b64_tr_b16 v[196:197], v18 offset:12288
  ds_read_b64_tr_b16 v[198:199], v18 offset:12544
  ds_read_b128 v[204:207], v25 offset:0
  s_waitcnt lgkmcnt(8)
  v_mfma_f32_32x32x16_bf16 v[160:175], v[44:47], v[120:123], v[160:175]
  ds_read_b64_tr_b16 v[36:37], v22 offset:4096
  ds_read_b64_tr_b16 v[38:39], v22 offset:6144
  ds_read_b128 v[104:107], v24 offset:1024
  s_waitcnt lgkmcnt(10)
  v_mfma_f32_32x32x16_bf16 v[176:191], v[44:47], v[124:127], v[176:191]
  ds_read_b128 v[108:111], v24 offset:9216
  s_waitcnt lgkmcnt(8)
  v_mfma_f32_32x32x16_bf16 v[160:175], v[32:35], v[96:99], v[160:175]
  ds_read_b64_tr_b16 v[40:41], v22 offset:8192
  ds_read_b64_tr_b16 v[42:43], v22 offset:10240
  ds_read_b128 v[112:115], v24 offset:2048
  s_waitcnt lgkmcnt(10)
  v_mfma_f32_32x32x16_bf16 v[176:191], v[32:35], v[100:103], v[176:191]
  s_waitcnt lgkmcnt(7)
  v_mfma_f32_16x16x32_bf16 v[192:195], v[196:199], v[204:207], v[192:195]
  ds_read_b128 v[116:119], v24 offset:10240
  ds_read_b64_tr_b16 v[200:201], v18 offset:13312
  ds_read_b64_tr_b16 v[202:203], v18 offset:13568
  ds_read_b128 v[208:211], v25 offset:2048
  s_waitcnt lgkmcnt(8)
  v_mfma_f32_32x32x16_bf16 v[160:175], v[36:39], v[104:107], v[160:175]
  ds_read_b64_tr_b16 v[44:45], v22 offset:12288
  ds_read_b64_tr_b16 v[46:47], v22 offset:14336
  ds_read_b128 v[120:123], v24 offset:3072
  s_waitcnt lgkmcnt(10)
  v_mfma_f32_32x32x16_bf16 v[176:191], v[36:39], v[108:111], v[176:191]
  ds_read_b128 v[124:127], v24 offset:11264
  s_waitcnt lgkmcnt(8)
  v_mfma_f32_32x32x16_bf16 v[160:175], v[40:43], v[112:115], v[160:175]
  s_cmp_ge_u32 s92, 38
  s_cbranch_scc1 L_OK81
L_SP82:
  ds_read_b128 v[28:31], v2 offset:0
  s_waitcnt lgkmcnt(0)
  v_min3_u32 v28, v28, v29, v30
  v_min_u32 v28, v28, v31
  s_nop 0
  v_readfirstlane_b32 s92, v28
  s_add_i32 s93, s93, -1
  s_cmp_lt_i32 s93, 0
  s_cbranch_scc1 L_OK81
  s_cmp_ge_u32 s92, 38
  s_cbranch_scc0 L_SP82
L_OK81:
  v_add_u32 v22, 0x10000, v15
  ds_read_b64_tr_b16 v[32:33], v22 offset:0
  ds_read_b64_tr_b16 v[34:35], v22 offset:2048
  ds_read_b128 v[96:99], v24 offset:4096
  s_waitcnt lgkmcnt(10)
  v_mfma_f32_32x32x16_bf16 v[176:191], v[40:43], v[116:119], v[176:191]
  s_waitcnt lgkmcnt(7)
  v_mfma_f32_16x16x32_bf16 v[192:195], v[200:203], v[208:211], v[192:195]
  ds_read_b128 v[100:103], v24 offset:12288
  ds_read_b64_tr_b16 v[196:197], v18 offset:14336
  ds_read_b64_tr_b16 v[198:199], v18 offset:14592
  ds_read_b128 v[204:207], v25 offset:4096
  s_waitcnt lgkmcnt(8)
  v_mfma_f32_32x32x16_bf16 v[160:175], v[44:47], v[120:123], v[160:175]
  ds_read_b64_tr_b16 v[36:37], v22 offset:4096
  ds_read_b64_tr_b16 v[38:39], v22 offset:6144
  ds_read_b128 v[104:107], v24 offset:5120
  s_waitcnt lgkmcnt(10)
  v_mfma_f32_32x32x16_bf16 v[176:191], v[44:47], v[124:127], v[176:191]
  ds_read_b128 v[108:111], v24 offset:13312
  s_waitcnt lgkmcnt(8)
  v_mfma_f32_32x32x16_bf16 v[160:175], v[32:35], v[96:99], v[160:175]
  ds_read_b64_tr_b16 v[40:41], v22 offset:8192
  ds_read_b64_tr_b16 v[42:43], v22 offset:10240
  ds_read_b128 v[112:115], v24 offset:6144
  s_waitcnt lgkmcnt(10)
  v_mfma_f32_32x32x16_bf16 v[176:191], v[32:35], v[100:103], v[176:191]
  s_waitcnt lgkmcnt(7)
  v_mfma_f32_16x16x32_bf16 v[192:195], v[196:199], v[204:207], v[192:195]
  ds_read_b128 v[116:119], v24 offset:14336
  ds_read_b64_tr_b16 v[200:201], v18 offset:15360
  ds_read_b64_tr_b16 v[202:203], v18 offset:15616
  ds_read_b128 v[208:211], v25 offset:6144
  s_waitcnt lgkmcnt(8)
  v_mfma_f32_32x32x16_bf16 v[160:175], v[36:39], v[104:107], v[160:175]
  ds_read_b64_tr_b16 v[44:45], v22 offset:12288
  ds_read_b64_tr_b16 v[46:47], v22 offset:14336
  ds_read_b128 v[120:123], v24 offset:7168
  s_waitcnt lgkmcnt(10)
  v_mfma_f32_32x32x16_bf16 v[176:191], v[36:39], v[108:111], v[176:191]
  ds_read_b128 v[124:127], v24 offset:15360
  s_waitcnt lgkmcnt(8)
  v_mfma_f32_32x32x16_bf16 v[160:175], v[40:43], v[112:115], v[160:175]
  s_waitcnt lgkmcnt(7)
  v_mfma_f32_32x32x16_bf16 v[176:191], v[40:43], v[116:119], v[176:191]
  s_waitcnt lgkmcnt(4)
  v_mfma_f32_16x16x32_bf16 v[192:195], v[200:203], v[208:211], v[192:195]
  s_waitcnt lgkmcnt(1)
  v_mfma_f32_32x32x16_bf16 v[160:175], v[44:47], v[120:123], v[160:175]
  s_waitcnt lgkmcnt(0)
  v_mfma_f32_32x32x16_bf16 v[176:191], v[44:47], v[124:127], v[176:191]
  v_mov_b32 v67, s58
  v_mov_b32 v71, s58
  v_mov_b32 v75, s58
  v_mov_b32 v79, s58
  v_mov_b32 v83, s58
  v_mov_b32 v87, s58
  s_add_u32 s62, s69, 4096
  s_nop 4
  v_cvt_pk_bf16_f32 v64, v160, v161
  v_cvt_pk_bf16_f32 v65, v162, v163
  v_cvt_pk_bf16_f32 v66, v164, v165
  buffer_store_dwordx4 v[64:67], v27, s[28:31], s69 offen offset:0 sc1
  v_cvt_pk_bf16_f32 v68, v166, v167
  v_cvt_pk_bf16_f32 v69, v168, v169
  v_cvt_pk_bf16_f32 v70, v170, v171
  buffer_store_dwordx4 v[68:71], v27, s[28:31], s69 offen offset:1024 sc1
  v_cvt_pk_bf16_f32 v72, v172, v173
  v_cvt_pk_bf16_f32 v73, v174, v175
  v_cvt_pk_bf16_f32 v74, v176, v177
  buffer_store_dwordx4 v[72:75], v27, s[28:31], s69 offen offset:2048 sc1
  v_cvt_pk_bf16_f32 v76, v178, v179
  v_cvt_pk_bf16_f32 v77, v180, v181
  v_cvt_pk_bf16_f32 v78, v182, v183
  buffer_store_dwordx4 v[76:79], v27, s[28:31], s69 offen offset:3072 sc1
  v_cvt_pk_bf16_f32 v80, v184, v185
  v_cvt_pk_bf16_f32 v81, v186, v187
  v_cvt_pk_bf16_f32 v82, v188, v189
  buffer_store_dwordx4 v[80:83], v27, s[28:31], s62 offen offset:0 sc1
  v_cvt_pk_bf16_f32 v84, v190, v191
  v_cvt_pk_bf16_f32 v85, v192, v193
  v_cvt_pk_bf16_f32 v86, v194, v195
  buffer_store_dwordx4 v[84:87], v27, s[28:31], s62 offen offset:1024 sc1
  v_mov_b32 v28, 36
  s_mov_b64 exec, 1
  ds_write_b32 v3, v28 offset:16
  s_mov_b64 exec, -1
  s_branch L_CEND
L_FINAL:
  s_cmp_ge_u32 s56, 7
  s_cbranch_scc1 L_FIN_SKIP
  s_mul_i32 s68, s52, 3
  s_add_u32 s68, s68, s57
  s_mul_i32 s69, s68, 43
  s_lshr_b32 s69, s69, 8
  s_mul_i32 s60, s69, 6
  s_sub_u32 s70, s68, s60
  s_mul_i32 s60, s69, 6144
  s_lshl_b32 s61, s70, 10
  s_add_u32 s60, s60, s61
  s_andn2_b32 s61, s59, 7
  s_mul_i32 s61, s61, 24576
  s_add_u32 s61, s61, s60
  s_add_u32 s67, s61, 0x800000
  v_lshlrev_b32 v5, 4, v1
  s_mov_b32 s63, 0
L_FW:
  ds_read_b128 v[104:107], v24 offset:16
  s_waitcnt lgkmcnt(0)
  v_min3_u32 v104, v104, v105, v106
  v_min_u32 v104, v104, v107
  s_nop 0
  v_readfirstlane_b32 s92, v104
  s_add_i32 s93, s93, -1
  s_cmp_lt_i32 s93, 0
  s_cbranch_scc1 L_FW_X
  s_cmp_ge_u32 s92, 36
  s_cbranch_scc1 L_FW_X
  s_sleep 1
  s_branch L_FW
L_FW_X:
  s_mov_b32 s61, s67
  buffer_load_dwordx4 v[32:35], v5, s[28:31], s61 offen sc1
  s_add_u32 s61, s61, 24576
  buffer_load_dwordx4 v[36:39], v5, s[28:31], s61 offen sc1
  s_add_u32 s61, s61, 24576
  buffer_load_dwordx4 v[40:43], v5, s[28:31], s61 offen sc1
  s_add_u32 s61, s61, 24576
  buffer_load_dwordx4 v[44:47], v5, s[28:31], s61 offen sc1
  s_add_u32 s61, s61, 24576
  buffer_load_dwordx4 v[48:51], v5, s[28:31], s61 offen sc1
  s_add_u32 s61, s61, 24576
  buffer_load_dwordx4 v[52:55], v5, s[28:31], s61 offen sc1
  s_add_u32 s61, s61, 24576
  buffer_load_dwordx4 v[56:59], v5, s[28:31], s61 offen sc1
  s_add_u32 s61, s61, 24576
  buffer_load_dwordx4 v[60:63], v5, s[28:31], s61 offen sc1
  v_and_b32 v6, 31, v1
  v_mul_u32_u24 v6, 1152, v6
  v_lshrrev_b32 v7, 5, v1
  v_lshl_add_u32 v6, v7, 3, v6
  v_and_b32 v7, 15, v1
  v_mul_u32_u24 v7, 1152, v7
  v_lshrrev_b32 v8, 4, v1
  v_lshl_add_u32 v7, v8, 3, v7
  s_mul_i32 s60, s70, 3
  s_add_u32 s60, s60, 0
  s_bfe_u32 s61, s60, 0x20001
  s_lshl_b32 s61, s61, 3
  s_and_b32 s62, s60, 1
  s_lshl_b32 s62, s62, 1
  s_add_u32 s61, s61, s62
  s_lshl_b32 s62, s69, 5
  s_add_u32 s61, s61, s62
  s_lshl_b32 s62, s53, 7
  s_add_u32 s61, s61, s62
  s_lshr_b32 s62, s60, 3
  s_and_b32 s62, s62, 1
  s_lshl_b32 s62, s62, 5
  s_lshl_b32 s8, s54, 6
  s_add_u32 s62, s62, s8
  s_mul_i32 s62, s62, 1152
  s_lshl_b32 s61, s61, 1
  s_add_u32 s8, s61, s62
  s_sub_u32 s61, s60, 16
  s_lshl_b32 s61, s61, 1
  s_lshl_b32 s62, s53, 4
  s_add_u32 s61, s61, s62
  s_add_u32 s61, s61, 512
  s_lshl_b32 s61, s61, 1
  s_lshl_b32 s62, s69, 4
  s_lshl_b32 s12, s54, 6
  s_add_u32 s62, s62, s12
  s_mul_i32 s62, s62, 1152
  s_add_u32 s61, s61, s62
  s_cmp_ge_u32 s60, 16
  s_cselect_b32 s8, s61, s8
  s_cselect_b32 s12, 1, 0
  s_mul_i32 s60, s70, 3
  s_add_u32 s60, s60, 1
  s_bfe_u32 s61, s60, 0x20001
  s_lshl_b32 s61, s61, 3
  s_and_b32 s62, s60, 1
  s_lshl_b32 s62, s62, 1
  s_add_u32 s61, s61, s62
  s_lshl_b32 s62, s69, 5
  s_add_u32 s61, s61, s62
  s_lshl_b32 s62, s53, 7
  s_add_u32 s61, s61, s62
  s_lshr_b32 s62, s60, 3
  s_and_b32 s62, s62, 1
  s_lshl_b32 s62, s62, 5
  s_lshl_b32 s9, s54, 6
  s_add_u32 s62, s62, s9
  s_mul_i32 s62, s62, 1152
  s_lshl_b32 s61, s61, 1
  s_add_u32 s9, s61, s62
  s_sub_u32 s61, s60, 16
  s_lshl_b32 s61, s61, 1
  s_lshl_b32 s62, s53, 4
  s_add_u32 s61, s61, s62
  s_add_u32 s61, s61, 512
  s_lshl_b32 s61, s61, 1
  s_lshl_b32 s62, s69, 4
  s_lshl_b32 s13, s54, 6
  s_add_u32 s62, s62, s13
  s_mul_i32 s62, s62, 1152
  s_add_u32 s61, s61, s62
  s_cmp_ge_u32 s60, 16
  s_cselect_b32 s9, s61, s9
  s_cselect_b32 s13, 1, 0
  s_mul_i32 s60, s70, 3
  s_add_u32 s60, s60, 2
  s_bfe_u32 s61, s60, 0x20001
  s_lshl_b32 s61, s61, 3
  s_and_b32 s62, s60, 1
  s_lshl_b32 s62, s62, 1
  s_add_u32 s61, s61, s62
  s_lshl_b32 s62, s69, 5
  s_add_u32 s61, s61, s62
  s_lshl_b32 s62, s53, 7
  s_add_u32 s61, s61, s62
  s_lshr_b32 s62, s60, 3
  s_and_b32 s62, s62, 1
  s_lshl_b32 s62, s62, 5
  s_lshl_b32 s10, s54, 6
  s_add_u32 s62, s62, s10
  s_mul_i32 s62, s62, 1152
  s_lshl_b32 s61, s61, 1
  s_add_u32 s10, s61, s62
  s_sub_u32 s61, s60, 16
  s_lshl_b32 s61, s61, 1
  s_lshl_b32 s62, s53, 4
  s_add_u32 s61, s61, s62
  s_add_u32 s61, s61, 512
  s_lshl_b32 s61, s61, 1
  s_lshl_b32 s62, s69, 4
  s_lshl_b32 s14, s54, 6
  s_add_u32 s62, s62, s14
  s_mul_i32 s62, s62, 1152
  s_add_u32 s61, s61, s62
  s_cmp_ge_u32 s60, 16
  s_cselect_b32 s10, s61, s10
  s_cselect_b32 s14, 1, 0
  s_branch L_FIN_CHK
L_FIN_RETRY:
  s_mov_b32 s61, s67
  buffer_load_dwordx4 v[32:35], v5, s[28:31], s61 offen sc1
  s_add_u32 s61, s61, 24576
  buffer_load_dwordx4 v[36:39], v5, s[28:31], s61 offen sc1
  s_add_u32 s61, s61, 24576
  buffer_load_dwordx4 v[40:43], v5, s[28:31], s61 offen sc1
  s_add_u32 s61, s61, 24576
  buffer_load_dwordx4 v[44:47], v5, s[28:31], s61 offen sc1
  s_add_u32 s61, s61, 24576
  buffer_load_dwordx4 v[48:51], v5, s[28:31], s61 offen sc1
  s_add_u32 s61, s61, 24576
  buffer_load_dwordx4 v[52:55], v5, s[28:31], s61 offen sc1
  s_add_u32 s61, s61, 24576
  buffer_load_dwordx4 v[56:59], v5, s[28:31], s61 offen sc1
  s_add_u32 s61, s61, 24576
  buffer_load_dwordx4 v[60:63], v5, s[28:31], s61 offen sc1
L_FIN_CHK:
  s_waitcnt vmcnt(0)
  v_xor_b32 v12, s58, v35
  v_xor_b32 v13, s58, v39
  v_or_b32 v12, v13, v12
  v_xor_b32 v13, s58, v43
  v_or_b32 v12, v13, v12
  v_xor_b32 v13, s58, v47
  v_or_b32 v12, v13, v12
  v_xor_b32 v13, s58, v51
  v_or_b32 v12, v13, v12
  v_xor_b32 v13, s58, v55
  v_or_b32 v12, v13, v12
  v_xor_b32 v13, s58, v59
  v_or_b32 v12, v13, v12
  v_xor_b32 v13, s58, v63
  v_or_b32 v12, v13, v12
  v_cmp_ne_u32 vcc, 0, v12
  s_add_u32 s63, s63, 1
  s_cmp_gt_u32 s63, 40000
  s_cbranch_scc1 L_FIN_GO
  s_cbranch_vccnz L_FIN_RETRY
L_FIN_GO:
  v_lshlrev_b32 v64, 16, v32
  v_and_b32 v65, 0xffff0000, v32
  v_lshlrev_b32 v74, 16, v36
  v_and_b32 v75, 0xffff0000, v36
  v_pk_add_f32 v[64:65], v[64:65], v[74:75]
  v_lshlrev_b32 v76, 16, v40
  v_and_b32 v77, 0xffff0000, v40
  v_pk_add_f32 v[64:65], v[64:65], v[76:77]
  v_lshlrev_b32 v72, 16, v44
  v_and_b32 v73, 0xffff0000, v44
  v_pk_add_f32 v[64:65], v[64:65], v[72:73]
  v_lshlrev_b32 v74, 16, v48
  v_and_b32 v75, 0xffff0000, v48
  v_pk_add_f32 v[64:65], v[64:65], v[74:75]
  v_lshlrev_b32 v76, 16, v52
  v_and_b32 v77, 0xffff0000, v52
  v_pk_add_f32 v[64:65], v[64:65], v[76:77]
  v_lshlrev_b32 v72, 16, v56
  v_and_b32 v73, 0xffff0000, v56
  v_pk_add_f32 v[64:65], v[64:65], v[72:73]
  v_lshlrev_b32 v74, 16, v60
  v_and_b32 v75, 0xffff0000, v60
  v_pk_add_f32 v[64:65], v[64:65], v[74:75]
  v_cvt_pk_bf16_f32 v80, v64, v65
  s_cmp_eq_u32 s12, 1
  s_cselect_b64 vcc, -1, 0
  v_cndmask_b32 v84, v6, v7, vcc
  buffer_store_dword v80, v84, s[32:35], s8 offen
  v_lshlrev_b32 v66, 16, v33
  v_and_b32 v67, 0xffff0000, v33
  v_lshlrev_b32 v76, 16, v37
  v_and_b32 v77, 0xffff0000, v37
  v_pk_add_f32 v[66:67], v[66:67], v[76:77]
  v_lshlrev_b32 v72, 16, v41
  v_and_b32 v73, 0xffff0000, v41
  v_pk_add_f32 v[66:67], v[66:67], v[72:73]
  v_lshlrev_b32 v74, 16, v45
  v_and_b32 v75, 0xffff0000, v45
  v_pk_add_f32 v[66:67], v[66:67], v[74:75]
  v_lshlrev_b32 v76, 16, v49
  v_and_b32 v77, 0xffff0000, v49
  v_pk_add_f32 v[66:67], v[66:67], v[76:77]
  v_lshlrev_b32 v72, 16, v53
  v_and_b32 v73, 0xffff0000, v53
  v_pk_add_f32 v[66:67], v[66:67], v[72:73]
  v_lshlrev_b32 v74, 16, v57
  v_and_b32 v75, 0xffff0000, v57
  v_pk_add_f32 v[66:67], v[66:67], v[74:75]
  v_lshlrev_b32 v76, 16, v61
  v_and_b32 v77, 0xffff0000, v61
  v_pk_add_f32 v[66:67], v[66:67], v[76:77]
  v_cvt_pk_bf16_f32 v81, v66, v67
  s_cmp_eq_u32 s13, 1
  s_cselect_b64 vcc, -1, 0
  v_cndmask_b32 v85, v6, v7, vcc
  buffer_store_dword v81, v85, s[32:35], s9 offen
  v_lshlrev_b32 v68, 16, v34
  v_and_b32 v69, 0xffff0000, v34
  v_lshlrev_b32 v72, 16, v38
  v_and_b32 v73, 0xffff0000, v38
  v_pk_add_f32 v[68:69], v[68:69], v[72:73]
  v_lshlrev_b32 v74, 16, v42
  v_and_b32 v75, 0xffff0000, v42
  v_pk_add_f32 v[68:69], v[68:69], v[74:75]
  v_lshlrev_b32 v76, 16, v46
  v_and_b32 v77, 0xffff0000, v46
  v_pk_add_f32 v[68:69], v[68:69], v[76:77]
  v_lshlrev_b32 v72, 16, v50
  v_and_b32 v73, 0xffff0000, v50
  v_pk_add_f32 v[68:69], v[68:69], v[72:73]
  v_lshlrev_b32 v74, 16, v54
  v_and_b32 v75, 0xffff0000, v54
  v_pk_add_f32 v[68:69], v[68:69], v[74:75]
  v_lshlrev_b32 v76, 16, v58
  v_and_b32 v77, 0xffff0000, v58
  v_pk_add_f32 v[68:69], v[68:69], v[76:77]
  v_lshlrev_b32 v72, 16, v62
  v_and_b32 v73, 0xffff0000, v62
  v_pk_add_f32 v[68:69], v[68:69], v[72:73]
  v_cvt_pk_bf16_f32 v82, v68, v69
  s_cmp_eq_u32 s14, 1
  s_cselect_b64 vcc, -1, 0
  v_cndmask_b32 v86, v6, v7, vcc
  buffer_store_dword v82, v86, s[32:35], s10 offen
  s_and_b32 s60, s59, 31
  s_cmp_eq_u32 s60, 0
  s_cbranch_scc0 L_FIN_SKIP
  s_cmp_eq_u32 s56, 4
  s_cbranch_scc0 L_FIN_SKIP
  s_lshl_b32 s60, s54, 7
  v_mov_b32 v4, s58
  v_mov_b32 v5, 0
  s_mov_b64 exec, 1
  buffer_store_dword v4, v5, s[28:31], s60 offen sc1
  s_mov_b64 exec, -1
L_FIN_SKIP:
L_CEND:
L_END:
  s_endpgm

.section .rodata,"a"
.p2align 6
.amdhsa_kernel standalone__gqa_block_cached__near_ridge_kernel
  .amdhsa_next_free_vgpr 256
  .amdhsa_next_free_sgpr 96
  .amdhsa_accum_offset 256
  .amdhsa_group_segment_fixed_size 0
  .amdhsa_kernarg_size 64
  .amdhsa_user_sgpr_count 2
  .amdhsa_user_sgpr_kernarg_segment_ptr 1
  .amdhsa_system_sgpr_workgroup_id_x 1
.end_amdhsa_kernel
```
